```python
import torch

def _softmax(x, axis=-1):
    return torch.softmax(x, dim=axis)
def _gelu(x):
    return torch.nn.functional.gelu(x, approximate="tanh")
def _silu(x):
    return torch.nn.functional.silu(x)
def _sigmoid(x):
    return torch.sigmoid(x)
def _layernorm(x, axis=-1, eps=1e-5):
    m = x.mean(dim=axis, keepdim=True)
    v = x.var(dim=axis, keepdim=True, unbiased=False)
    return (x - m) / torch.sqrt(v + eps)
def _scatter_add(tgt, idx, src, axis=0):
    return tgt.clone().index_add_(axis, idx, src)
def _segment_sum(src, seg, n):
    out = torch.zeros((n,) + src.shape[1:], dtype=src.dtype)
    return out.index_add_(0, seg, src)
def _pad(x, pw):
    flat = tuple(v for pair in reversed(pw) for v in pair)
    return torch.nn.functional.pad(x, flat)

kernel_name = 'standalone__molecular_angular_gemnet__graph'

def setup_inputs():

    _w = (lambda a: (lambda t: t.to(torch.bfloat16) if t.is_floating_point() else t)(torch.as_tensor(a)))
    N, deg, De, L = 10000, 16, 4, 3
    E = N * deg
    T = E * deg
    NR = 8
    dist = torch.rand(E).to(float)
    angle = (torch.rand(T) * torch.pi).to(float)
    centers = torch.linspace(0.0, 1.0, NR).to(float)
    ang_freq = torch.arange(1, L + 1).to(float)
    return {
        "m": _w((lambda *s: torch.randn(*s, dtype=torch.bfloat16) * 0.05)(E, De)),
        "idx_in": _w((lambda lo, hi, *s: torch.randint(lo, hi, s))(0, E, T).to(torch.int64)),
        "idx_out": _w((lambda lo, hi, *s: torch.randint(lo, hi, s))(0, E, T).to(torch.int64)),
        "dist": _w(dist),
        "angle": _w(angle),
        "centers": _w(centers),
        "ang_freq": _w(ang_freq),
        "w_rbf": _w((lambda *s: torch.randn(*s, dtype=torch.bfloat16) * 0.2)(NR, De)),
        "w_sbf": _w((lambda *s: torch.randn(*s, dtype=torch.bfloat16) * 0.2)(NR * L, De)),
        "w_down": _w((lambda *s: torch.randn(*s, dtype=torch.bfloat16) * 0.2)(De, De)),
        "w_up": _w((lambda *s: torch.randn(*s, dtype=torch.bfloat16) * 0.2)(De, De)),
    }

def reference(m, idx_in, idx_out, dist, angle, centers, ang_freq, w_rbf, w_sbf, w_down, w_up):
    E, De = m.shape[0], m.shape[1]
    NR = centers.shape[0]
    L = ang_freq.shape[0]
    rbf = torch.exp(-10.0 * (dist[:, None] - centers[None, :]) ** 2)
    cbf = torch.cos(ang_freq[None, :] * angle[:, None])
    rbf_t = rbf[idx_out]
    sbf = torch.reshape(rbf_t[:, :, None] * cbf[:, None, :], (-1, NR * L))
    x = (m[idx_in] @ w_down) * (sbf @ w_sbf)
    agg = _segment_sum(x, idx_out, E)
    return m + (agg @ w_up) * (rbf @ w_rbf)
```

```asm
; @launch kernel=standalone__molecular_angular_gemnet__graph_part_kernel grid=(256,1,1) block=(1024,1,1) lds=62464
; @launch kernel=standalone__molecular_angular_gemnet__graph_kernel grid=(256,1,1) block=(1024,1,1) lds=163328
.amdgcn_target "amdgcn-amd-amdhsa--gfx950"
.text
.globl standalone__molecular_angular_gemnet__graph_part_kernel
.p2align 8
.type standalone__molecular_angular_gemnet__graph_part_kernel,@function
standalone__molecular_angular_gemnet__graph_part_kernel:
    s_cmp_ge_u32 s2, 256
    s_cbranch_scc1 L_k1_done
    s_load_dwordx2 s[4:5], s[0:1], 0
    s_load_dwordx4 s[8:11], s[0:1], 8
    s_load_dwordx2 s[12:13], s[0:1], 32
    s_load_dwordx2 s[28:29], s[0:1], 104
    v_lshlrev_b32 v1, 4, v0
    v_lshlrev_b32 v2, 3, v0
    v_lshlrev_b32 v3, 2, v0
    v_and_b32 v4, 63, v0
    v_lshlrev_b32 v4, 4, v4
    v_mov_b32 v5, 6
    v_lshrrev_b32 v7, 6, v0
    v_mov_b32 v40, 0
    v_mov_b32 v41, 0
    v_readfirstlane_b32 s40, v7
    v_mov_b32 v42, 0
    v_mov_b32 v43, 0
    s_waitcnt lgkmcnt(0)
    s_mul_i32 s41, s2, 40000
    s_add_u32 s32, s10, s41
    s_addc_u32 s33, s11, 0
    s_mov_b32 s34, 40000
    s_mov_b32 s35, 0x20000
    s_movk_i32 s41, 0x4000
    buffer_load_dwordx4 v[10:13], v1, s[32:35], 0 offen
    buffer_load_dwordx4 v[14:17], v1, s[32:35], s41 offen
    s_mov_b32 s41, 0x8000
    buffer_load_dwordx2 v[18:19], v2, s[32:35], s41 offen
    ds_write_b128 v4, v[40:43] offset:0
    s_waitcnt lgkmcnt(0)
    s_barrier
    s_mul_i32 s41, s2, 40000
    s_add_u32 s36, s8, s41
    s_addc_u32 s37, s9, 0
    s_mov_b32 s38, 40000
    s_mov_b32 s39, 0x20000
    s_movk_i32 s41, 0x4000
    buffer_load_dwordx4 v[20:23], v1, s[36:39], 0 offen
    buffer_load_dwordx4 v[24:27], v1, s[36:39], s41 offen
    s_mov_b32 s41, 0x8000
    buffer_load_dwordx2 v[28:29], v2, s[36:39], s41 offen
    s_mul_i32 s41, s2, 20000
    s_add_u32 s32, s12, s41
    s_addc_u32 s33, s13, 0
    s_mov_b32 s34, 20000
    s_mov_b32 s35, 0x20000
    s_movk_i32 s41, 0x2000
    buffer_load_dwordx2 v[30:31], v2, s[32:35], 0 offen
    buffer_load_dwordx2 v[32:33], v2, s[32:35], s41 offen
    s_movk_i32 s41, 0x4000
    buffer_load_dword v34, v3, s[32:35], s41 offen
    s_mov_b32 s20, 6871948
    s_movk_i32 s21, -625
    v_cmp_gt_u32 vcc, 904, v0
    s_mov_b64 s[44:45], vcc
    s_waitcnt vmcnt(8)
    v_mul_hi_u32 v60, v10, s20
    v_mul_hi_u32 v61, v11, s20
    v_mul_hi_u32 v62, v12, s20
    v_mul_hi_u32 v63, v13, s20
    v_lshlrev_b32 v40, 2, v60
    ds_add_rtn_u32 v50, v40, v5 offset:0
    v_lshlrev_b32 v10, 2, v10
    v_mad_i32_i24 v10, v40, s21, v10
    v_lshlrev_b32 v41, 2, v61
    ds_add_rtn_u32 v51, v41, v5 offset:0
    v_lshlrev_b32 v11, 2, v11
    v_mad_i32_i24 v11, v41, s21, v11
    v_lshlrev_b32 v42, 2, v62
    ds_add_rtn_u32 v52, v42, v5 offset:0
    v_lshlrev_b32 v12, 2, v12
    v_mad_i32_i24 v12, v42, s21, v12
    v_lshlrev_b32 v43, 2, v63
    ds_add_rtn_u32 v53, v43, v5 offset:0
    v_lshlrev_b32 v13, 2, v13
    v_mad_i32_i24 v13, v43, s21, v13
    s_waitcnt vmcnt(7)
    v_mul_hi_u32 v64, v14, s20
    v_mul_hi_u32 v65, v15, s20
    v_mul_hi_u32 v66, v16, s20
    v_mul_hi_u32 v67, v17, s20
    v_lshlrev_b32 v44, 2, v64
    ds_add_rtn_u32 v54, v44, v5 offset:0
    v_lshlrev_b32 v14, 2, v14
    v_mad_i32_i24 v14, v44, s21, v14
    v_lshlrev_b32 v45, 2, v65
    ds_add_rtn_u32 v55, v45, v5 offset:0
    v_lshlrev_b32 v15, 2, v15
    v_mad_i32_i24 v15, v45, s21, v15
    v_lshlrev_b32 v46, 2, v66
    ds_add_rtn_u32 v56, v46, v5 offset:0
    v_lshlrev_b32 v16, 2, v16
    v_mad_i32_i24 v16, v46, s21, v16
    v_lshlrev_b32 v47, 2, v67
    ds_add_rtn_u32 v57, v47, v5 offset:0
    v_lshlrev_b32 v17, 2, v17
    v_mad_i32_i24 v17, v47, s21, v17
    s_waitcnt vmcnt(6)
    s_mov_b64 exec, s[44:45]
    v_mul_hi_u32 v68, v18, s20
    v_mul_hi_u32 v69, v19, s20
    v_lshlrev_b32 v48, 2, v68
    ds_add_rtn_u32 v58, v48, v5 offset:0
    v_lshlrev_b32 v18, 2, v18
    v_mad_i32_i24 v18, v48, s21, v18
    v_lshlrev_b32 v49, 2, v69
    ds_add_rtn_u32 v59, v49, v5 offset:0
    v_lshlrev_b32 v19, 2, v19
    v_mad_i32_i24 v19, v49, s21, v19
    s_mov_b64 exec, -1
    s_waitcnt lgkmcnt(0)
    s_barrier
    ds_read_b128 v[60:63], v4 offset:0
    s_waitcnt lgkmcnt(0)
    v_add3_u32 v64, v60, v61, v62
    v_add_u32 v64, v64, v63
    v_mov_b32 v65, v64
    s_nop 1
    v_add_u32_dpp v64, v64, v64 row_shr:1 row_mask:0xf bank_mask:0xf bound_ctrl:0
    s_nop 1
    v_add_u32_dpp v64, v64, v64 row_shr:2 row_mask:0xf bank_mask:0xf bound_ctrl:0
    s_nop 1
    v_add_u32_dpp v64, v64, v64 row_shr:4 row_mask:0xf bank_mask:0xf bound_ctrl:0
    s_nop 1
    v_add_u32_dpp v64, v64, v64 row_shr:8 row_mask:0xf bank_mask:0xf bound_ctrl:0
    s_nop 1
    v_add_u32_dpp v64, v64, v64 row_bcast:15 row_mask:0xa bank_mask:0xf
    s_nop 1
    v_add_u32_dpp v64, v64, v64 row_bcast:31 row_mask:0xc bank_mask:0xf
    v_sub_u32 v84, v64, v65
    v_add_u32 v85, v84, v60
    v_add_u32 v86, v85, v61
    v_add_u32 v87, v86, v62
    ds_write_b128 v4, v[84:87] offset:1024
    s_waitcnt lgkmcnt(0)
    ds_read_b32 v70, v40 offset:1024
    ds_read_b32 v71, v41 offset:1024
    ds_read_b32 v72, v42 offset:1024
    ds_read_b32 v73, v43 offset:1024
    ds_read_b32 v74, v44 offset:1024
    ds_read_b32 v75, v45 offset:1024
    ds_read_b32 v76, v46 offset:1024
    ds_read_b32 v77, v47 offset:1024
    s_mov_b64 exec, s[44:45]
    ds_read_b32 v78, v48 offset:1024
    ds_read_b32 v79, v49 offset:1024
    s_mov_b64 exec, -1
    s_waitcnt lgkmcnt(0)
    s_movk_i32 s22, -2
    v_add_u32 v70, v70, v50
    v_and_b32 v60, 2, v70
    v_mad_i32_i24 v50, v60, s22, v70
    v_add_u32 v70, v70, v60
    v_add_u32 v71, v71, v51
    v_and_b32 v61, 2, v71
    v_mad_i32_i24 v51, v61, s22, v71
    v_add_u32 v71, v71, v61
    v_add_u32 v72, v72, v52
    v_and_b32 v62, 2, v72
    v_mad_i32_i24 v52, v62, s22, v72
    v_add_u32 v72, v72, v62
    v_add_u32 v73, v73, v53
    v_and_b32 v63, 2, v73
    v_mad_i32_i24 v53, v63, s22, v73
    v_add_u32 v73, v73, v63
    v_add_u32 v74, v74, v54
    v_and_b32 v64, 2, v74
    v_mad_i32_i24 v54, v64, s22, v74
    v_add_u32 v74, v74, v64
    v_add_u32 v75, v75, v55
    v_and_b32 v65, 2, v75
    v_mad_i32_i24 v55, v65, s22, v75
    v_add_u32 v75, v75, v65
    v_add_u32 v76, v76, v56
    v_and_b32 v66, 2, v76
    v_mad_i32_i24 v56, v66, s22, v76
    v_add_u32 v76, v76, v66
    v_add_u32 v77, v77, v57
    v_and_b32 v67, 2, v77
    v_mad_i32_i24 v57, v67, s22, v77
    v_add_u32 v77, v77, v67
    v_add_u32 v78, v78, v58
    v_and_b32 v68, 2, v78
    v_mad_i32_i24 v58, v68, s22, v78
    v_add_u32 v78, v78, v68
    v_add_u32 v79, v79, v59
    v_and_b32 v69, 2, v79
    v_mad_i32_i24 v59, v69, s22, v79
    v_add_u32 v79, v79, v69
    s_waitcnt vmcnt(5)
    v_lshl_or_b32 v20, v20, 12, v10
    ds_write_b32 v70, v20 offset:2048
    v_lshl_or_b32 v21, v21, 12, v11
    ds_write_b32 v71, v21 offset:2048
    v_lshl_or_b32 v22, v22, 12, v12
    ds_write_b32 v72, v22 offset:2048
    v_lshl_or_b32 v23, v23, 12, v13
    ds_write_b32 v73, v23 offset:2048
    s_waitcnt vmcnt(4)
    v_lshl_or_b32 v24, v24, 12, v14
    ds_write_b32 v74, v24 offset:2048
    v_lshl_or_b32 v25, v25, 12, v15
    ds_write_b32 v75, v25 offset:2048
    v_lshl_or_b32 v26, v26, 12, v16
    ds_write_b32 v76, v26 offset:2048
    v_lshl_or_b32 v27, v27, 12, v17
    ds_write_b32 v77, v27 offset:2048
    s_waitcnt vmcnt(3)
    s_mov_b64 exec, s[44:45]
    v_lshl_or_b32 v28, v28, 12, v18
    ds_write_b32 v78, v28 offset:2048
    v_lshl_or_b32 v29, v29, 12, v19
    ds_write_b32 v79, v29 offset:2048
    s_mov_b64 exec, -1
    s_waitcnt vmcnt(2)
    ds_write_b16 v50, v30 offset:2052
    ds_write_b16_d16_hi v51, v30 offset:2052
    ds_write_b16 v52, v31 offset:2052
    ds_write_b16_d16_hi v53, v31 offset:2052
    s_waitcnt vmcnt(1)
    ds_write_b16 v54, v32 offset:2052
    ds_write_b16_d16_hi v55, v32 offset:2052
    ds_write_b16 v56, v33 offset:2052
    ds_write_b16_d16_hi v57, v33 offset:2052
    s_waitcnt vmcnt(0)
    s_mov_b64 exec, s[44:45]
    ds_write_b16 v58, v34 offset:2052
    ds_write_b16_d16_hi v59, v34 offset:2052
    s_mov_b64 exec, -1
    s_cmp_lg_u32 s40, 0
    s_cbranch_scc1 L_o_1
    s_mov_b32 s36, s28
    s_mov_b32 s37, s29
    s_mov_b32 s38, 0x40000
    s_mov_b32 s39, 0x20000
    s_lshl_b32 s41, s2, 10
    buffer_store_dwordx4 v[84:87], v4, s[36:39], s41 offen sc1
L_o_1:
    s_waitcnt lgkmcnt(0)
    s_barrier
    s_mul_i32 s41, s2, 60032
    s_add_u32 s36, s28, 0x40000
    s_addc_u32 s37, s29, 0
    s_add_u32 s36, s36, s41
    s_addc_u32 s37, s37, 0
    s_mov_b32 s38, 60000
    s_mov_b32 s39, 0x20000
    ds_read_b128 v[40:43], v1 offset:2048
    ds_read_b128 v[44:47], v1 offset:18432
    ds_read_b128 v[48:51], v1 offset:34816
    s_mov_b32 s20, 0
    s_mov_b32 s21, 16384
    s_mov_b32 s22, 32768
    s_mov_b32 s23, 49152
    s_cmp_ge_u32 s40, 11
    s_cbranch_scc1 L_w_2
    ds_read_b128 v[52:55], v1 offset:51200
    s_waitcnt lgkmcnt(0)
    buffer_store_dwordx4 v[52:55], v1, s[36:39], s23 offen sc1
L_w_2:
    s_waitcnt lgkmcnt(2)
    buffer_store_dwordx4 v[40:43], v1, s[36:39], s20 offen sc1
    s_waitcnt lgkmcnt(1)
    buffer_store_dwordx4 v[44:47], v1, s[36:39], s21 offen sc1
    s_waitcnt lgkmcnt(0)
    buffer_store_dwordx4 v[48:51], v1, s[36:39], s22 offen sc1
L_k1_done:
    s_endpgm
.globl standalone__molecular_angular_gemnet__graph_kernel
.p2align 8
.type standalone__molecular_angular_gemnet__graph_kernel,@function
standalone__molecular_angular_gemnet__graph_kernel:
    s_cmp_ge_u32 s2, 256
    s_cbranch_scc1 L_k2_done
    s_and_b32 s4, s2, 7
    s_lshl_b32 s4, s4, 5
    s_lshr_b32 s5, s2, 3
    s_add_u32 s3, s4, s5
    s_cmp_ge_u32 s3, 256
    s_cbranch_scc1 L_k2_done
    s_load_dwordx2 s[28:29], s[0:1], 104
    s_load_dwordx16 s[4:19], s[0:1], 0
    s_load_dwordx8 s[20:27], s[0:1], 64
    v_and_b32 v1, 63, v0
    v_lshrrev_b32 v62, 6, v0
    v_and_b32 v2, 31, v0
    v_readfirstlane_b32 s48, v62
    v_mul_u32_u24 v2, 12, v2
    v_lshlrev_b32 v4, 2, v0
    v_lshlrev_b32 v5, 3, v0
    v_lshlrev_b32 v6, 4, v0
    v_mov_b32 v9, 1
    v_and_b32 v62, 7, v1
    v_lshrrev_b32 v63, 5, v1
    v_lshl_add_u32 v62, v62, 1, v63
    v_lshlrev_b32 v62, 4, v62
    v_add_u32 v62, s48, v62
    s_lshl_b32 s49, s3, 2
    v_lshl_add_u32 v63, v62, 10, s49
    v_mov_b32 v70, 0
    v_mov_b32 v71, 0
    v_mov_b32 v72, 0
    v_mov_b32 v73, 0
    v_lshlrev_b32 v66, 1, v0
    v_mov_b32 v74, 29184
    v_cmp_gt_u32 vcc, 48, v0
    v_mov_b32 v67, 0
    s_nop 0
    v_cndmask_b32 v74, 0, v74, vcc
    v_mov_b32 v75, v74
    v_mov_b32 v76, v74
    v_mov_b32 v77, v74
    v_cmpx_gt_u32 vcc, 64, v0
    ds_write_b128 v6, v[74:77] offset:0
    s_mov_b64 exec, -1
    v_cmpx_gt_u32 vcc, 160, v0
    ds_write_b128 v6, v[70:73] offset:1024
    s_mov_b64 exec, -1
    v_cmpx_gt_u32 vcc, 640, v0
    ds_write_b128 v6, v[70:73] offset:18944
    s_mov_b64 exec, -1
    s_waitcnt lgkmcnt(0)
    s_barrier
    s_mov_b32 s32, s28
    s_mov_b32 s33, s29
    s_mov_b32 s34, 0x40000
    s_mov_b32 s35, 0x20000
    buffer_load_dwordx2 v[64:65], v63, s[32:35], 0 offen
    s_mov_b32 s36, s10
    s_mov_b32 s37, s11
    s_mov_b32 s38, 0x4e200
    s_mov_b32 s39, 0x20000
    s_mul_i32 s49, s3, 1250
    buffer_load_ushort v95, v66, s[36:39], s49 offen
    s_mov_b32 s40, s4
    s_or_b32 s41, s5, 0x80000
    s_mov_b32 s42, 160000
    s_mov_b32 s43, 0x20000
    s_mov_b64 s[30:31], s[18:19]
    s_cmp_ge_u32 s48, 10
    s_cbranch_scc1 L_wl_3
    s_load_dwordx16 s[52:67], s[20:21], 0
    s_load_dwordx16 s[68:83], s[20:21], 64
    s_load_dwordx16 s[84:99], s[20:21], 128
    s_load_dwordx4 s[44:47], s[14:15], 0
    s_load_dwordx16 s[4:19], s[30:31], 0
L_wl_3:
    s_add_u32 s36, s28, 0x40000
    s_addc_u32 s37, s29, 0
    s_mov_b32 s38, 0xea8000
    s_mov_b32 s39, 0x20000
    s_mov_b32 s49, 60032
    v_mul_lo_u32 v63, v62, s49
    v_and_b32 v69, 31, v1
    v_cmp_eq_u32 vcc, 0, v69
    v_lshlrev_b32 v68, 1, v69
    v_mov_b32 v69, 0x10000
    s_movk_i32 s49, -3
    v_cndmask_b32 v69, 0, v69, vcc
    s_waitcnt vmcnt(1)
    s_cmp_lg_u32 s3, 255
    s_cbranch_scc1 L_lastb_4
    v_mov_b32 v65, 60000
L_lastb_4:
    v_and_b32 v66, 2, v64
    v_mad_i32_i24 v64, v66, s49, v64
    v_sub_u32 v8, v65, v64
    v_add_u32 v7, v63, v64
    v_min_u32 v8, 60000, v8
    v_mul_u32_u24 v8, 43691, v8
    v_lshlrev_b32 v104, 15, v66
    v_lshrrev_b32 v8, 18, v8
    s_nop 1
    v_sub_u32_dpp v54, v8, v68 row_newbcast:0 row_mask:0xf bank_mask:0xf
    v_add_u32_dpp v82, v7, v2 row_newbcast:0 row_mask:0xf bank_mask:0xf
    v_cmp_lt_i32 vcc, 0, v54
    s_mov_b64 exec, vcc
    buffer_load_dwordx3 v[10:12], v82, s[36:39], 0 offen
    s_mov_b64 exec, -1
    v_sub_u32_dpp v55, v8, v68 row_newbcast:1 row_mask:0xf bank_mask:0xf
    v_add_u32_dpp v83, v7, v2 row_newbcast:1 row_mask:0xf bank_mask:0xf
    v_sub_u32_dpp v56, v8, v68 row_newbcast:2 row_mask:0xf bank_mask:0xf
    v_add_u32_dpp v84, v7, v2 row_newbcast:2 row_mask:0xf bank_mask:0xf
    v_sub_u32_dpp v57, v8, v68 row_newbcast:3 row_mask:0xf bank_mask:0xf
    v_add_u32_dpp v85, v7, v2 row_newbcast:3 row_mask:0xf bank_mask:0xf
    v_sub_u32_dpp v58, v8, v68 row_newbcast:4 row_mask:0xf bank_mask:0xf
    v_add_u32_dpp v86, v7, v2 row_newbcast:4 row_mask:0xf bank_mask:0xf
    v_sub_u32_dpp v59, v8, v68 row_newbcast:5 row_mask:0xf bank_mask:0xf
    v_add_u32_dpp v87, v7, v2 row_newbcast:5 row_mask:0xf bank_mask:0xf
    v_sub_u32_dpp v60, v8, v68 row_newbcast:6 row_mask:0xf bank_mask:0xf
    v_add_u32_dpp v88, v7, v2 row_newbcast:6 row_mask:0xf bank_mask:0xf
    v_sub_u32_dpp v61, v8, v68 row_newbcast:7 row_mask:0xf bank_mask:0xf
    v_add_u32_dpp v89, v7, v2 row_newbcast:7 row_mask:0xf bank_mask:0xf
    s_mov_b32 s20, 5149841
    s_movk_i32 s21, 520
    s_mov_b32 s50, 29696
    s_mov_b32 s51, 162304
    v_mov_b32 v53, 8
    v_mov_b32 v52, 768
    v_cmp_lt_i32 vcc, 0, v55
    s_mov_b64 exec, vcc
    buffer_load_dwordx3 v[14:16], v83, s[36:39], 0 offen
    s_mov_b64 exec, -1
    s_waitcnt vmcnt(1)
    v_and_b32_dpp v50, v104, v69 row_newbcast:0 row_mask:0xf bank_mask:0xf
    v_cmp_lt_i32 s[32:33], 1, v54
    v_cmp_gt_i32 s[30:31], v54, v50
    v_and_b32 v13, 0xffff0000, v11
    v_lshlrev_b32 v11, 16, v11
    s_mov_b64 exec, s[30:31]
    v_lshrrev_b32 v50, 12, v10
    v_mul_hi_u32 v42, v50, s20
    v_lshlrev_b32 v50, 2, v42
    ds_add_rtn_u32 v46, v50, v53 offset:0
    s_mov_b64 exec, s[32:33]
    v_lshrrev_b32 v50, 12, v12
    v_mul_hi_u32 v43, v50, s20
    v_lshlrev_b32 v50, 2, v43
    ds_add_rtn_u32 v47, v50, v53 offset:0
    s_mov_b64 exec, -1
    v_cmp_lt_i32 vcc, 0, v56
    s_mov_b64 exec, vcc
    buffer_load_dwordx3 v[18:20], v84, s[36:39], 0 offen
    s_mov_b64 exec, -1
    s_waitcnt vmcnt(1)
    v_and_b32_dpp v50, v104, v69 row_newbcast:1 row_mask:0xf bank_mask:0xf
    v_cmp_lt_i32 s[0:1], 1, v55
    v_cmp_gt_i32 s[34:35], v55, v50
    v_and_b32 v17, 0xffff0000, v15
    v_lshlrev_b32 v15, 16, v15
    s_mov_b64 exec, s[34:35]
    v_lshrrev_b32 v50, 12, v14
    v_mul_hi_u32 v44, v50, s20
    v_lshlrev_b32 v50, 2, v44
    ds_add_rtn_u32 v48, v50, v53 offset:0
    s_mov_b64 exec, s[0:1]
    v_lshrrev_b32 v50, 12, v16
    v_mul_hi_u32 v45, v50, s20
    v_lshlrev_b32 v50, 2, v45
    ds_add_rtn_u32 v49, v50, v53 offset:0
    s_mov_b64 exec, -1
    s_waitcnt lgkmcnt(2)
    s_mov_b64 exec, s[30:31]
    v_mad_u32_u24 v50, v42, s21, v46
    v_cmpx_gt_u32 vcc, s50, v46
    ds_write_b64 v50, v[10:11]
    s_andn2_b64 exec, s[30:31], exec
    s_cbranch_scc0 L_so_5
    ds_add_rtn_u32 v50, v52, v9
    s_waitcnt lgkmcnt(0)
    v_cmpx_gt_u32 vcc, 128, v50
    v_lshl_add_u32 v50, v50, 3, s51
    ds_write_b64 v50, v[10:11]
    s_nop 2
L_so_5:
    s_mov_b64 exec, s[32:33]
    v_mad_u32_u24 v50, v43, s21, v47
    v_cmpx_gt_u32 vcc, s50, v47
    ds_write_b64 v50, v[12:13]
    s_andn2_b64 exec, s[32:33], exec
    s_cbranch_scc0 L_so_6
    ds_add_rtn_u32 v50, v52, v9
    s_waitcnt lgkmcnt(0)
    v_cmpx_gt_u32 vcc, 128, v50
    v_lshl_add_u32 v50, v50, 3, s51
    ds_write_b64 v50, v[12:13]
    s_nop 2
L_so_6:
    s_mov_b64 exec, -1
    v_cmp_lt_i32 vcc, 0, v57
    s_mov_b64 exec, vcc
    buffer_load_dwordx3 v[22:24], v85, s[36:39], 0 offen
    s_mov_b64 exec, -1
    s_waitcnt vmcnt(1)
    v_and_b32_dpp v50, v104, v69 row_newbcast:2 row_mask:0xf bank_mask:0xf
    v_cmp_lt_i32 s[32:33], 1, v56
    v_cmp_gt_i32 s[30:31], v56, v50
    v_and_b32 v21, 0xffff0000, v19
    v_lshlrev_b32 v19, 16, v19
    s_mov_b64 exec, s[30:31]
    v_lshrrev_b32 v50, 12, v18
    v_mul_hi_u32 v42, v50, s20
    v_lshlrev_b32 v50, 2, v42
    ds_add_rtn_u32 v46, v50, v53 offset:0
    s_mov_b64 exec, s[32:33]
    v_lshrrev_b32 v50, 12, v20
    v_mul_hi_u32 v43, v50, s20
    v_lshlrev_b32 v50, 2, v43
    ds_add_rtn_u32 v47, v50, v53 offset:0
    s_mov_b64 exec, -1
    s_waitcnt lgkmcnt(2)
    s_mov_b64 exec, s[34:35]
    v_mad_u32_u24 v50, v44, s21, v48
    v_cmpx_gt_u32 vcc, s50, v48
    ds_write_b64 v50, v[14:15]
    s_andn2_b64 exec, s[34:35], exec
    s_cbranch_scc0 L_so_7
    ds_add_rtn_u32 v50, v52, v9
    s_waitcnt lgkmcnt(0)
    v_cmpx_gt_u32 vcc, 128, v50
    v_lshl_add_u32 v50, v50, 3, s51
    ds_write_b64 v50, v[14:15]
    s_nop 2
L_so_7:
    s_mov_b64 exec, s[0:1]
    v_mad_u32_u24 v50, v45, s21, v49
    v_cmpx_gt_u32 vcc, s50, v49
    ds_write_b64 v50, v[16:17]
    s_andn2_b64 exec, s[0:1], exec
    s_cbranch_scc0 L_so_8
    ds_add_rtn_u32 v50, v52, v9
    s_waitcnt lgkmcnt(0)
    v_cmpx_gt_u32 vcc, 128, v50
    v_lshl_add_u32 v50, v50, 3, s51
    ds_write_b64 v50, v[16:17]
    s_nop 2
L_so_8:
    s_mov_b64 exec, -1
    v_cmp_lt_i32 vcc, 0, v58
    s_mov_b64 exec, vcc
    buffer_load_dwordx3 v[26:28], v86, s[36:39], 0 offen
    s_mov_b64 exec, -1
    s_waitcnt vmcnt(1)
    v_and_b32_dpp v50, v104, v69 row_newbcast:3 row_mask:0xf bank_mask:0xf
    v_cmp_lt_i32 s[0:1], 1, v57
    v_cmp_gt_i32 s[34:35], v57, v50
    v_and_b32 v25, 0xffff0000, v23
    v_lshlrev_b32 v23, 16, v23
    s_mov_b64 exec, s[34:35]
    v_lshrrev_b32 v50, 12, v22
    v_mul_hi_u32 v44, v50, s20
    v_lshlrev_b32 v50, 2, v44
    ds_add_rtn_u32 v48, v50, v53 offset:0
    s_mov_b64 exec, s[0:1]
    v_lshrrev_b32 v50, 12, v24
    v_mul_hi_u32 v45, v50, s20
    v_lshlrev_b32 v50, 2, v45
    ds_add_rtn_u32 v49, v50, v53 offset:0
    s_mov_b64 exec, -1
    s_waitcnt lgkmcnt(2)
    s_mov_b64 exec, s[30:31]
    v_mad_u32_u24 v50, v42, s21, v46
    v_cmpx_gt_u32 vcc, s50, v46
    ds_write_b64 v50, v[18:19]
    s_andn2_b64 exec, s[30:31], exec
    s_cbranch_scc0 L_so_9
    ds_add_rtn_u32 v50, v52, v9
    s_waitcnt lgkmcnt(0)
    v_cmpx_gt_u32 vcc, 128, v50
    v_lshl_add_u32 v50, v50, 3, s51
    ds_write_b64 v50, v[18:19]
    s_nop 2
L_so_9:
    s_mov_b64 exec, s[32:33]
    v_mad_u32_u24 v50, v43, s21, v47
    v_cmpx_gt_u32 vcc, s50, v47
    ds_write_b64 v50, v[20:21]
    s_andn2_b64 exec, s[32:33], exec
    s_cbranch_scc0 L_so_10
    ds_add_rtn_u32 v50, v52, v9
    s_waitcnt lgkmcnt(0)
    v_cmpx_gt_u32 vcc, 128, v50
    v_lshl_add_u32 v50, v50, 3, s51
    ds_write_b64 v50, v[20:21]
    s_nop 2
L_so_10:
    s_mov_b64 exec, -1
    v_cmp_lt_i32 vcc, 0, v59
    s_mov_b64 exec, vcc
    buffer_load_dwordx3 v[30:32], v87, s[36:39], 0 offen
    s_mov_b64 exec, -1
    s_waitcnt vmcnt(1)
    v_and_b32_dpp v50, v104, v69 row_newbcast:4 row_mask:0xf bank_mask:0xf
    v_cmp_lt_i32 s[32:33], 1, v58
    v_cmp_gt_i32 s[30:31], v58, v50
    v_and_b32 v29, 0xffff0000, v27
    v_lshlrev_b32 v27, 16, v27
    s_mov_b64 exec, s[30:31]
    v_lshrrev_b32 v50, 12, v26
    v_mul_hi_u32 v42, v50, s20
    v_lshlrev_b32 v50, 2, v42
    ds_add_rtn_u32 v46, v50, v53 offset:0
    s_mov_b64 exec, s[32:33]
    v_lshrrev_b32 v50, 12, v28
    v_mul_hi_u32 v43, v50, s20
    v_lshlrev_b32 v50, 2, v43
    ds_add_rtn_u32 v47, v50, v53 offset:0
    s_mov_b64 exec, -1
    s_waitcnt lgkmcnt(2)
    s_mov_b64 exec, s[34:35]
    v_mad_u32_u24 v50, v44, s21, v48
    v_cmpx_gt_u32 vcc, s50, v48
    ds_write_b64 v50, v[22:23]
    s_andn2_b64 exec, s[34:35], exec
    s_cbranch_scc0 L_so_11
    ds_add_rtn_u32 v50, v52, v9
    s_waitcnt lgkmcnt(0)
    v_cmpx_gt_u32 vcc, 128, v50
    v_lshl_add_u32 v50, v50, 3, s51
    ds_write_b64 v50, v[22:23]
    s_nop 2
L_so_11:
    s_mov_b64 exec, s[0:1]
    v_mad_u32_u24 v50, v45, s21, v49
    v_cmpx_gt_u32 vcc, s50, v49
    ds_write_b64 v50, v[24:25]
    s_andn2_b64 exec, s[0:1], exec
    s_cbranch_scc0 L_so_12
    ds_add_rtn_u32 v50, v52, v9
    s_waitcnt lgkmcnt(0)
    v_cmpx_gt_u32 vcc, 128, v50
    v_lshl_add_u32 v50, v50, 3, s51
    ds_write_b64 v50, v[24:25]
    s_nop 2
L_so_12:
    s_mov_b64 exec, -1
    v_cmp_lt_i32 vcc, 0, v60
    s_mov_b64 exec, vcc
    buffer_load_dwordx3 v[34:36], v88, s[36:39], 0 offen
    s_mov_b64 exec, -1
    s_waitcnt vmcnt(1)
    v_and_b32_dpp v50, v104, v69 row_newbcast:5 row_mask:0xf bank_mask:0xf
    v_cmp_lt_i32 s[0:1], 1, v59
    v_cmp_gt_i32 s[34:35], v59, v50
    v_and_b32 v33, 0xffff0000, v31
    v_lshlrev_b32 v31, 16, v31
    s_mov_b64 exec, s[34:35]
    v_lshrrev_b32 v50, 12, v30
    v_mul_hi_u32 v44, v50, s20
    v_lshlrev_b32 v50, 2, v44
    ds_add_rtn_u32 v48, v50, v53 offset:0
    s_mov_b64 exec, s[0:1]
    v_lshrrev_b32 v50, 12, v32
    v_mul_hi_u32 v45, v50, s20
    v_lshlrev_b32 v50, 2, v45
    ds_add_rtn_u32 v49, v50, v53 offset:0
    s_mov_b64 exec, -1
    s_waitcnt lgkmcnt(2)
    s_mov_b64 exec, s[30:31]
    v_mad_u32_u24 v50, v42, s21, v46
    v_cmpx_gt_u32 vcc, s50, v46
    ds_write_b64 v50, v[26:27]
    s_andn2_b64 exec, s[30:31], exec
    s_cbranch_scc0 L_so_13
    ds_add_rtn_u32 v50, v52, v9
    s_waitcnt lgkmcnt(0)
    v_cmpx_gt_u32 vcc, 128, v50
    v_lshl_add_u32 v50, v50, 3, s51
    ds_write_b64 v50, v[26:27]
    s_nop 2
L_so_13:
    s_mov_b64 exec, s[32:33]
    v_mad_u32_u24 v50, v43, s21, v47
    v_cmpx_gt_u32 vcc, s50, v47
    ds_write_b64 v50, v[28:29]
    s_andn2_b64 exec, s[32:33], exec
    s_cbranch_scc0 L_so_14
    ds_add_rtn_u32 v50, v52, v9
    s_waitcnt lgkmcnt(0)
    v_cmpx_gt_u32 vcc, 128, v50
    v_lshl_add_u32 v50, v50, 3, s51
    ds_write_b64 v50, v[28:29]
    s_nop 2
L_so_14:
    s_mov_b64 exec, -1
    v_cmp_lt_i32 vcc, 0, v61
    s_mov_b64 exec, vcc
    buffer_load_dwordx3 v[38:40], v89, s[36:39], 0 offen
    s_mov_b64 exec, -1
    s_waitcnt vmcnt(1)
    v_and_b32_dpp v50, v104, v69 row_newbcast:6 row_mask:0xf bank_mask:0xf
    v_cmp_lt_i32 s[32:33], 1, v60
    v_cmp_gt_i32 s[30:31], v60, v50
    v_and_b32 v37, 0xffff0000, v35
    v_lshlrev_b32 v35, 16, v35
    s_mov_b64 exec, s[30:31]
    v_lshrrev_b32 v50, 12, v34
    v_mul_hi_u32 v42, v50, s20
    v_lshlrev_b32 v50, 2, v42
    ds_add_rtn_u32 v46, v50, v53 offset:0
    s_mov_b64 exec, s[32:33]
    v_lshrrev_b32 v50, 12, v36
    v_mul_hi_u32 v43, v50, s20
    v_lshlrev_b32 v50, 2, v43
    ds_add_rtn_u32 v47, v50, v53 offset:0
    s_mov_b64 exec, -1
    s_waitcnt lgkmcnt(2)
    s_mov_b64 exec, s[34:35]
    v_mad_u32_u24 v50, v44, s21, v48
    v_cmpx_gt_u32 vcc, s50, v48
    ds_write_b64 v50, v[30:31]
    s_andn2_b64 exec, s[34:35], exec
    s_cbranch_scc0 L_so_15
    ds_add_rtn_u32 v50, v52, v9
    s_waitcnt lgkmcnt(0)
    v_cmpx_gt_u32 vcc, 128, v50
    v_lshl_add_u32 v50, v50, 3, s51
    ds_write_b64 v50, v[30:31]
    s_nop 2
L_so_15:
    s_mov_b64 exec, s[0:1]
    v_mad_u32_u24 v50, v45, s21, v49
    v_cmpx_gt_u32 vcc, s50, v49
    ds_write_b64 v50, v[32:33]
    s_andn2_b64 exec, s[0:1], exec
    s_cbranch_scc0 L_so_16
    ds_add_rtn_u32 v50, v52, v9
    s_waitcnt lgkmcnt(0)
    v_cmpx_gt_u32 vcc, 128, v50
    v_lshl_add_u32 v50, v50, 3, s51
    ds_write_b64 v50, v[32:33]
    s_nop 2
L_so_16:
    s_mov_b64 exec, -1
    s_waitcnt lgkmcnt(0)
    s_mov_b64 exec, s[30:31]
    v_mad_u32_u24 v50, v42, s21, v46
    v_cmpx_gt_u32 vcc, s50, v46
    ds_write_b64 v50, v[34:35]
    s_andn2_b64 exec, s[30:31], exec
    s_cbranch_scc0 L_so_17
    ds_add_rtn_u32 v50, v52, v9
    s_waitcnt lgkmcnt(0)
    v_cmpx_gt_u32 vcc, 128, v50
    v_lshl_add_u32 v50, v50, 3, s51
    ds_write_b64 v50, v[34:35]
    s_nop 2
L_so_17:
    s_mov_b64 exec, s[32:33]
    v_mad_u32_u24 v50, v43, s21, v47
    v_cmpx_gt_u32 vcc, s50, v47
    ds_write_b64 v50, v[36:37]
    s_andn2_b64 exec, s[32:33], exec
    s_cbranch_scc0 L_so_18
    ds_add_rtn_u32 v50, v52, v9
    s_waitcnt lgkmcnt(0)
    v_cmpx_gt_u32 vcc, 128, v50
    v_lshl_add_u32 v50, v50, 3, s51
    ds_write_b64 v50, v[36:37]
    s_nop 2
L_so_18:
    s_mov_b64 exec, -1
    s_waitcnt vmcnt(0)
    v_and_b32_dpp v50, v104, v69 row_newbcast:7 row_mask:0xf bank_mask:0xf
    v_cmp_lt_i32 s[0:1], 1, v61
    v_sub_u32 v106, v61, v50
    v_and_b32 v41, 0xffff0000, v39
    v_cmp_lt_i32 s[34:35], 0, v106
    v_lshlrev_b32 v39, 16, v39
    s_mov_b64 exec, s[34:35]
    v_lshrrev_b32 v50, 12, v38
    buffer_load_dwordx2 v[108:109], v50, s[40:43], 0 idxen
    s_mov_b64 exec, s[0:1]
    v_lshrrev_b32 v50, 12, v40
    buffer_load_dwordx2 v[110:111], v50, s[40:43], 0 idxen
    s_mov_b64 exec, -1
    s_mov_b64 exec, -1
    s_cmp_ge_u32 s48, 10
    s_cbranch_scc1 L_join_19
    v_lshlrev_b32 v95, 16, v95
    s_mov_b32 s30, 0xc166d4ca
    s_lshl_b32 s49, s44, 16
    v_subrev_f32 v62, s49, v95
    v_mul_f32 v62, v62, v62
    v_mul_f32 v62, s30, v62
    v_exp_f32 v62, v62
    s_and_b32 s49, s44, 0xffff0000
    v_subrev_f32 v63, s49, v95
    v_mul_f32 v63, v63, v63
    v_mul_f32 v63, s30, v63
    v_exp_f32 v63, v63
    s_lshl_b32 s49, s45, 16
    v_subrev_f32 v64, s49, v95
    v_mul_f32 v64, v64, v64
    v_mul_f32 v64, s30, v64
    v_exp_f32 v64, v64
    s_and_b32 s49, s45, 0xffff0000
    v_subrev_f32 v65, s49, v95
    v_mul_f32 v65, v65, v65
    v_mul_f32 v65, s30, v65
    v_exp_f32 v65, v65
    s_lshl_b32 s49, s46, 16
    v_subrev_f32 v66, s49, v95
    v_mul_f32 v66, v66, v66
    v_mul_f32 v66, s30, v66
    v_exp_f32 v66, v66
    s_and_b32 s49, s46, 0xffff0000
    v_subrev_f32 v67, s49, v95
    v_mul_f32 v67, v67, v67
    v_mul_f32 v67, s30, v67
    v_exp_f32 v67, v67
    s_lshl_b32 s49, s47, 16
    v_subrev_f32 v68, s49, v95
    v_mul_f32 v68, v68, v68
    v_mul_f32 v68, s30, v68
    v_exp_f32 v68, v68
    s_and_b32 s49, s47, 0xffff0000
    v_subrev_f32 v69, s49, v95
    v_mul_f32 v69, v69, v69
    v_mul_f32 v69, s30, v69
    v_exp_f32 v69, v69
    s_nop 0
    v_cvt_pk_bf16_f32 v70, v62, v63
    v_cvt_pk_bf16_f32 v71, v64, v65
    v_cvt_pk_bf16_f32 v72, v66, v67
    v_cvt_pk_bf16_f32 v73, v68, v69
    s_pack_ll_b32_b16 s20, s52, s58
    v_dot2_f32_bf16 v42, v70, s20, 0
    s_pack_hh_b32_b16 s21, s52, s58
    v_dot2_f32_bf16 v43, v70, s21, 0
    s_pack_ll_b32_b16 s50, s53, s59
    v_dot2_f32_bf16 v44, v70, s50, 0
    s_pack_hh_b32_b16 s51, s53, s59
    v_dot2_f32_bf16 v45, v70, s51, 0
    s_pack_ll_b32_b16 s20, s54, s60
    v_dot2_f32_bf16 v46, v70, s20, 0
    s_pack_hh_b32_b16 s21, s54, s60
    v_dot2_f32_bf16 v47, v70, s21, 0
    s_pack_ll_b32_b16 s50, s55, s61
    v_dot2_f32_bf16 v48, v70, s50, 0
    s_pack_hh_b32_b16 s51, s55, s61
    v_dot2_f32_bf16 v49, v70, s51, 0
    s_pack_ll_b32_b16 s20, s56, s62
    v_dot2_f32_bf16 v50, v70, s20, 0
    s_pack_hh_b32_b16 s21, s56, s62
    v_dot2_f32_bf16 v51, v70, s21, 0
    s_pack_ll_b32_b16 s50, s57, s63
    v_dot2_f32_bf16 v52, v70, s50, 0
    s_pack_hh_b32_b16 s51, s57, s63
    v_dot2_f32_bf16 v53, v70, s51, 0
    s_pack_ll_b32_b16 s20, s4, s6
    v_dot2_f32_bf16 v78, v70, s20, 0
    s_pack_hh_b32_b16 s21, s4, s6
    v_dot2_f32_bf16 v79, v70, s21, 0
    s_pack_ll_b32_b16 s50, s5, s7
    v_dot2_f32_bf16 v80, v70, s50, 0
    s_pack_hh_b32_b16 s51, s5, s7
    v_dot2_f32_bf16 v81, v70, s51, 0
    s_pack_ll_b32_b16 s20, s64, s70
    v_dot2c_f32_bf16 v42, s20, v71
    s_pack_hh_b32_b16 s21, s64, s70
    v_dot2c_f32_bf16 v43, s21, v71
    s_pack_ll_b32_b16 s50, s65, s71
    v_dot2c_f32_bf16 v44, s50, v71
    s_pack_hh_b32_b16 s51, s65, s71
    v_dot2c_f32_bf16 v45, s51, v71
    s_pack_ll_b32_b16 s20, s66, s72
    v_dot2c_f32_bf16 v46, s20, v71
    s_pack_hh_b32_b16 s21, s66, s72
    v_dot2c_f32_bf16 v47, s21, v71
    s_pack_ll_b32_b16 s50, s67, s73
    v_dot2c_f32_bf16 v48, s50, v71
    s_pack_hh_b32_b16 s51, s67, s73
    v_dot2c_f32_bf16 v49, s51, v71
    s_pack_ll_b32_b16 s20, s68, s74
    v_dot2c_f32_bf16 v50, s20, v71
    s_pack_hh_b32_b16 s21, s68, s74
    v_dot2c_f32_bf16 v51, s21, v71
    s_pack_ll_b32_b16 s50, s69, s75
    v_dot2c_f32_bf16 v52, s50, v71
    s_pack_hh_b32_b16 s51, s69, s75
    v_dot2c_f32_bf16 v53, s51, v71
    s_pack_ll_b32_b16 s20, s8, s10
    v_dot2c_f32_bf16 v78, s20, v71
    s_pack_hh_b32_b16 s21, s8, s10
    v_dot2c_f32_bf16 v79, s21, v71
    s_pack_ll_b32_b16 s50, s9, s11
    v_dot2c_f32_bf16 v80, s50, v71
    s_pack_hh_b32_b16 s51, s9, s11
    v_dot2c_f32_bf16 v81, s51, v71
    s_pack_ll_b32_b16 s20, s76, s82
    v_dot2c_f32_bf16 v42, s20, v72
    s_pack_hh_b32_b16 s21, s76, s82
    v_dot2c_f32_bf16 v43, s21, v72
    s_pack_ll_b32_b16 s50, s77, s83
    v_dot2c_f32_bf16 v44, s50, v72
    s_pack_hh_b32_b16 s51, s77, s83
    v_dot2c_f32_bf16 v45, s51, v72
    s_pack_ll_b32_b16 s20, s78, s84
    v_dot2c_f32_bf16 v46, s20, v72
    s_pack_hh_b32_b16 s21, s78, s84
    v_dot2c_f32_bf16 v47, s21, v72
    s_pack_ll_b32_b16 s50, s79, s85
    v_dot2c_f32_bf16 v48, s50, v72
    s_pack_hh_b32_b16 s51, s79, s85
    v_dot2c_f32_bf16 v49, s51, v72
    s_pack_ll_b32_b16 s20, s80, s86
    v_dot2c_f32_bf16 v50, s20, v72
    s_pack_hh_b32_b16 s21, s80, s86
    v_dot2c_f32_bf16 v51, s21, v72
    s_pack_ll_b32_b16 s50, s81, s87
    v_dot2c_f32_bf16 v52, s50, v72
    s_pack_hh_b32_b16 s51, s81, s87
    v_dot2c_f32_bf16 v53, s51, v72
    s_pack_ll_b32_b16 s20, s12, s14
    v_dot2c_f32_bf16 v78, s20, v72
    s_pack_hh_b32_b16 s21, s12, s14
    v_dot2c_f32_bf16 v79, s21, v72
    s_pack_ll_b32_b16 s50, s13, s15
    v_dot2c_f32_bf16 v80, s50, v72
    s_pack_hh_b32_b16 s51, s13, s15
    v_dot2c_f32_bf16 v81, s51, v72
    s_pack_ll_b32_b16 s20, s88, s94
    v_dot2c_f32_bf16 v42, s20, v73
    s_pack_hh_b32_b16 s21, s88, s94
    v_dot2c_f32_bf16 v43, s21, v73
    s_pack_ll_b32_b16 s50, s89, s95
    v_dot2c_f32_bf16 v44, s50, v73
    s_pack_hh_b32_b16 s51, s89, s95
    v_dot2c_f32_bf16 v45, s51, v73
    s_pack_ll_b32_b16 s20, s90, s96
    v_dot2c_f32_bf16 v46, s20, v73
    s_pack_hh_b32_b16 s21, s90, s96
    v_dot2c_f32_bf16 v47, s21, v73
    s_pack_ll_b32_b16 s50, s91, s97
    v_dot2c_f32_bf16 v48, s50, v73
    s_pack_hh_b32_b16 s51, s91, s97
    v_dot2c_f32_bf16 v49, s51, v73
    s_pack_ll_b32_b16 s20, s92, s98
    v_dot2c_f32_bf16 v50, s20, v73
    s_pack_hh_b32_b16 s21, s92, s98
    v_dot2c_f32_bf16 v51, s21, v73
    s_pack_ll_b32_b16 s50, s93, s99
    v_dot2c_f32_bf16 v52, s50, v73
    s_pack_hh_b32_b16 s51, s93, s99
    v_dot2c_f32_bf16 v53, s51, v73
    s_pack_ll_b32_b16 s20, s16, s18
    v_dot2c_f32_bf16 v78, s20, v73
    s_pack_hh_b32_b16 s21, s16, s18
    v_dot2c_f32_bf16 v79, s21, v73
    s_pack_ll_b32_b16 s50, s17, s19
    v_dot2c_f32_bf16 v80, s50, v73
    s_pack_hh_b32_b16 s51, s17, s19
    v_dot2c_f32_bf16 v81, s51, v73
    s_nop 2
    v_cvt_pk_bf16_f32 v64, v42, v46
    v_cvt_pk_bf16_f32 v65, v43, v47
    v_cvt_pk_bf16_f32 v66, v44, v48
    v_cvt_pk_bf16_f32 v67, v45, v49
    v_cvt_pk_bf16_f32 v62, v50, v51
    v_cvt_pk_bf16_f32 v63, v52, v53
    ds_write_b128 v6, v[64:67] offset:8704
    ds_write_b64 v5, v[62:63] offset:3584
    v_cvt_pk_bf16_f32 v96, v78, v79
    v_cvt_pk_bf16_f32 v97, v80, v81
L_join_19:
    v_mov_b32 v52, 768
    v_and_b32 v54, 15, v1
    s_mul_i32 s49, s48, 12
    v_add_u32 v54, s49, v54
    v_lshlrev_b32 v54, 2, v54
    v_lshlrev_b32 v55, 3, v1
    s_mul_i32 s49, s48, 6240
    s_add_u32 s49, s49, 29184
    v_add_u32 v50, s49, v55
    s_waitcnt lgkmcnt(0)
    s_barrier
    ds_read_b32 v54, v54 offset:0
    ds_read_b32 v52, v52
    ds_read_b64 v[10:11], v50 offset:0
    ds_read_b64 v[12:13], v50 offset:520
    ds_read_b64 v[14:15], v50 offset:1040
    ds_read_b64 v[16:17], v50 offset:1560
    ds_read_b64 v[18:19], v50 offset:2080
    ds_read_b64 v[20:21], v50 offset:2600
    ds_read_b64 v[22:23], v50 offset:3120
    ds_read_b64 v[24:25], v50 offset:3640
    ds_read_b64 v[26:27], v50 offset:4160
    ds_read_b64 v[28:29], v50 offset:4680
    ds_read_b64 v[30:31], v50 offset:5200
    ds_read_b64 v[32:33], v50 offset:5720
    s_waitcnt lgkmcnt(12)
    v_readfirstlane_b32 s31, v52
    v_subrev_u32 v54, 29184, v54
    v_min_u32 v54, 512, v54
    s_nop 1
    v_mov_b32_dpp v56, v54 row_newbcast:0 row_mask:0xf bank_mask:0xf
    v_cmp_gt_u32 s[4:5], v56, v55
    v_mov_b32_dpp v57, v54 row_newbcast:1 row_mask:0xf bank_mask:0xf
    v_cmp_gt_u32 s[6:7], v57, v55
    v_mov_b32_dpp v56, v54 row_newbcast:2 row_mask:0xf bank_mask:0xf
    v_cmp_gt_u32 s[8:9], v56, v55
    v_mov_b32_dpp v57, v54 row_newbcast:3 row_mask:0xf bank_mask:0xf
    v_cmp_gt_u32 s[10:11], v57, v55
    v_mov_b32_dpp v56, v54 row_newbcast:4 row_mask:0xf bank_mask:0xf
    v_cmp_gt_u32 s[12:13], v56, v55
    v_mov_b32_dpp v57, v54 row_newbcast:5 row_mask:0xf bank_mask:0xf
    v_cmp_gt_u32 s[14:15], v57, v55
    v_mov_b32_dpp v56, v54 row_newbcast:6 row_mask:0xf bank_mask:0xf
    v_cmp_gt_u32 s[16:17], v56, v55
    v_mov_b32_dpp v57, v54 row_newbcast:7 row_mask:0xf bank_mask:0xf
    v_cmp_gt_u32 s[18:19], v57, v55
    v_mov_b32_dpp v56, v54 row_newbcast:8 row_mask:0xf bank_mask:0xf
    v_cmp_gt_u32 s[84:85], v56, v55
    v_mov_b32_dpp v57, v54 row_newbcast:9 row_mask:0xf bank_mask:0xf
    v_cmp_gt_u32 s[86:87], v57, v55
    v_mov_b32_dpp v56, v54 row_newbcast:10 row_mask:0xf bank_mask:0xf
    v_cmp_gt_u32 s[88:89], v56, v55
    v_mov_b32_dpp v57, v54 row_newbcast:11 row_mask:0xf bank_mask:0xf
    v_cmp_gt_u32 s[90:91], v57, v55
    v_cmp_lt_i32 s[96:97], 0, v106
    v_cmp_lt_i32 s[98:99], 1, v61
    s_waitcnt lgkmcnt(0)
    s_load_dwordx8 s[52:59], s[22:23], 0
    s_load_dwordx8 s[68:75], s[24:25], 0
    s_cmp_gt_u32 s31, 128
    s_cbranch_scc1 L_eg_22
    s_mov_b64 exec, s[4:5]
    v_lshrrev_b32 v65, 12, v10
    buffer_load_dwordx2 v[42:43], v65, s[40:43], 0 idxen
    v_and_b32 v100, 0xffc, v10
    ds_add_rtn_u32 v50, v100, v9 offset:1024
    s_mov_b64 exec, s[6:7]
    v_lshrrev_b32 v65, 12, v12
    buffer_load_dwordx2 v[44:45], v65, s[40:43], 0 idxen
    v_and_b32 v101, 0xffc, v12
    ds_add_rtn_u32 v51, v101, v9 offset:1024
    s_mov_b64 exec, s[8:9]
    v_lshrrev_b32 v65, 12, v14
    buffer_load_dwordx2 v[46:47], v65, s[40:43], 0 idxen
    v_and_b32 v102, 0xffc, v14
    ds_add_rtn_u32 v52, v102, v9 offset:1024
L_eg_22:
    s_mov_b64 exec, -1
    s_waitcnt lgkmcnt(0)
    s_pack_ll_b32_b16 s60, s52, s54
    s_pack_ll_b32_b16 s64, s56, s58
    s_pack_hh_b32_b16 s61, s52, s54
    s_pack_hh_b32_b16 s65, s56, s58
    s_pack_ll_b32_b16 s62, s53, s55
    s_pack_ll_b32_b16 s66, s57, s59
    s_pack_hh_b32_b16 s63, s53, s55
    s_pack_hh_b32_b16 s67, s57, s59
    s_mov_b32 s80, 5120
    s_mov_b32 s81, 0x3e22f983
    s_barrier
    s_mov_b32 s32, s40
    s_and_b32 s33, s41, 0xffff
    s_mov_b32 s34, 1280000
    s_mov_b32 s35, 0x20000
    s_mul_i32 s49, s3, 5000
    buffer_load_dwordx2 v[98:99], v5, s[32:35], s49 offen
    s_cmp_gt_u32 s31, 128
    s_cbranch_scc1 L_main_21
    s_mov_b64 exec, s[10:11]
    v_lshrrev_b32 v65, 12, v16
    buffer_load_dwordx2 v[48:49], v65, s[40:43], 0 idxen
    v_and_b32 v103, 0xffc, v16
    ds_add_rtn_u32 v53, v103, v9 offset:1024
    s_mov_b64 exec, s[96:97]
    v_and_b32 v118, 0xffc, v38
    ds_add_rtn_u32 v116, v118, v9 offset:1024
    s_mov_b64 exec, s[98:99]
    v_and_b32 v119, 0xffc, v40
    ds_add_rtn_u32 v117, v119, v9 offset:1024
    s_mov_b64 exec, s[96:97]
    v_lshlrev_b32 v64, 2, v118
    v_lshlrev_b32 v63, 1, v118
    ds_read_b128 v[66:69], v64 offset:8704
    ds_read_b64 v[70:71], v63 offset:3584
    v_mul_f32 v72, s81, v39
    v_fract_f32 v72, v72
    v_cos_f32 v72, v72
    s_nop 0
    v_add_f32 v75, v72, v72
    v_fma_f32 v73, v75, v72, -1.0
    v_fma_f32 v74, v75, v73, -v72
    v_cvt_pk_bf16_f32 v75, v72, v73
    v_cvt_pk_bf16_f32 v76, v74, 0
    v_lshlrev_b32 v77, 16, v76
    s_waitcnt lgkmcnt(0)
    v_dot2_f32_bf16 v78, v70, v76, 0
    v_dot2_f32_bf16 v79, v70, v77, 0
    v_dot2_f32_bf16 v80, v71, v76, 0
    v_dot2_f32_bf16 v81, v71, v77, 0
    v_mad_u32_u24 v65, v116, s80, v63
    s_nop 1
    v_dot2c_f32_bf16 v78, v66, v75
    v_dot2c_f32_bf16 v79, v67, v75
    v_dot2c_f32_bf16 v80, v68, v75
    v_dot2c_f32_bf16 v81, v69, v75
    s_waitcnt vmcnt(6)
    v_dot2_f32_bf16 v90, v108, s60, 0
    v_dot2_f32_bf16 v91, v108, s61, 0
    v_dot2_f32_bf16 v92, v108, s62, 0
    v_dot2_f32_bf16 v93, v108, s63, 0
    v_dot2c_f32_bf16 v90, s64, v109
    v_dot2c_f32_bf16 v91, s65, v109
    v_dot2c_f32_bf16 v92, s66, v109
    v_dot2c_f32_bf16 v93, s67, v109
    s_nop 0
    v_mul_f32 v90, v90, v78
    v_mul_f32 v91, v91, v79
    v_mul_f32 v92, v92, v80
    v_mul_f32 v93, v93, v81
    v_cvt_pk_bf16_f32 v94, v90, v91
    v_cvt_pk_bf16_f32 v95, v92, v93
    v_cmpx_gt_u32 vcc, 26, v116
    ds_write_b64 v65, v[94:95] offset:29184
    s_andn2_b64 exec, s[96:97], exec
    s_cbranch_scc0 L_ov_23
    ds_add_f32 v64, v90 offset:18944
    ds_add_f32 v64, v91 offset:18948
    ds_add_f32 v64, v92 offset:18952
    ds_add_f32 v64, v93 offset:18956
L_ov_23:
    s_mov_b64 exec, s[98:99]
    v_lshlrev_b32 v64, 2, v119
    v_lshlrev_b32 v63, 1, v119
    ds_read_b128 v[66:69], v64 offset:8704
    ds_read_b64 v[70:71], v63 offset:3584
    v_mul_f32 v72, s81, v41
    v_fract_f32 v72, v72
    v_cos_f32 v72, v72
    s_nop 0
    v_add_f32 v75, v72, v72
    v_fma_f32 v73, v75, v72, -1.0
    v_fma_f32 v74, v75, v73, -v72
    v_cvt_pk_bf16_f32 v75, v72, v73
    v_cvt_pk_bf16_f32 v76, v74, 0
    v_lshlrev_b32 v77, 16, v76
    s_waitcnt lgkmcnt(0)
    v_dot2_f32_bf16 v78, v70, v76, 0
    v_dot2_f32_bf16 v79, v70, v77, 0
    v_dot2_f32_bf16 v80, v71, v76, 0
    v_dot2_f32_bf16 v81, v71, v77, 0
    v_mad_u32_u24 v65, v117, s80, v63
    s_nop 1
    v_dot2c_f32_bf16 v78, v66, v75
    v_dot2c_f32_bf16 v79, v67, v75
    v_dot2c_f32_bf16 v80, v68, v75
    v_dot2c_f32_bf16 v81, v69, v75
    s_waitcnt vmcnt(5)
    v_dot2_f32_bf16 v90, v110, s60, 0
    v_dot2_f32_bf16 v91, v110, s61, 0
    v_dot2_f32_bf16 v92, v110, s62, 0
    v_dot2_f32_bf16 v93, v110, s63, 0
    v_dot2c_f32_bf16 v90, s64, v111
    v_dot2c_f32_bf16 v91, s65, v111
    v_dot2c_f32_bf16 v92, s66, v111
    v_dot2c_f32_bf16 v93, s67, v111
    s_nop 0
    v_mul_f32 v90, v90, v78
    v_mul_f32 v91, v91, v79
    v_mul_f32 v92, v92, v80
    v_mul_f32 v93, v93, v81
    v_cvt_pk_bf16_f32 v94, v90, v91
    v_cvt_pk_bf16_f32 v95, v92, v93
    v_cmpx_gt_u32 vcc, 26, v117
    ds_write_b64 v65, v[94:95] offset:29184
    s_andn2_b64 exec, s[98:99], exec
    s_cbranch_scc0 L_ov_24
    ds_add_f32 v64, v90 offset:18944
    ds_add_f32 v64, v91 offset:18948
    ds_add_f32 v64, v92 offset:18952
    ds_add_f32 v64, v93 offset:18956
L_ov_24:
    s_mov_b64 exec, s[4:5]
    v_lshlrev_b32 v64, 2, v100
    v_lshlrev_b32 v63, 1, v100
    ds_read_b128 v[66:69], v64 offset:8704
    ds_read_b64 v[70:71], v63 offset:3584
    v_mul_f32 v72, s81, v11
    v_fract_f32 v72, v72
    v_cos_f32 v72, v72
    s_nop 0
    v_add_f32 v75, v72, v72
    v_fma_f32 v73, v75, v72, -1.0
    v_fma_f32 v74, v75, v73, -v72
    v_cvt_pk_bf16_f32 v75, v72, v73
    v_cvt_pk_bf16_f32 v76, v74, 0
    v_lshlrev_b32 v77, 16, v76
    s_waitcnt lgkmcnt(0)
    v_dot2_f32_bf16 v78, v70, v76, 0
    v_dot2_f32_bf16 v79, v70, v77, 0
    v_dot2_f32_bf16 v80, v71, v76, 0
    v_dot2_f32_bf16 v81, v71, v77, 0
    v_mad_u32_u24 v65, v50, s80, v63
    s_nop 1
    v_dot2c_f32_bf16 v78, v66, v75
    v_dot2c_f32_bf16 v79, v67, v75
    v_dot2c_f32_bf16 v80, v68, v75
    v_dot2c_f32_bf16 v81, v69, v75
    s_waitcnt vmcnt(4)
    v_dot2_f32_bf16 v90, v42, s60, 0
    v_dot2_f32_bf16 v91, v42, s61, 0
    v_dot2_f32_bf16 v92, v42, s62, 0
    v_dot2_f32_bf16 v93, v42, s63, 0
    v_dot2c_f32_bf16 v90, s64, v43
    v_dot2c_f32_bf16 v91, s65, v43
    v_dot2c_f32_bf16 v92, s66, v43
    v_dot2c_f32_bf16 v93, s67, v43
    s_nop 0
    v_mul_f32 v90, v90, v78
    v_mul_f32 v91, v91, v79
    v_mul_f32 v92, v92, v80
    v_mul_f32 v93, v93, v81
    v_cvt_pk_bf16_f32 v94, v90, v91
    v_cvt_pk_bf16_f32 v95, v92, v93
    v_cmpx_gt_u32 vcc, 26, v50
    ds_write_b64 v65, v[94:95] offset:29184
    s_andn2_b64 exec, s[4:5], exec
    s_cbranch_scc0 L_ov_25
    ds_add_f32 v64, v90 offset:18944
    ds_add_f32 v64, v91 offset:18948
    ds_add_f32 v64, v92 offset:18952
    ds_add_f32 v64, v93 offset:18956
L_ov_25:
    s_mov_b64 exec, s[12:13]
    v_lshrrev_b32 v65, 12, v18
    buffer_load_dwordx2 v[42:43], v65, s[40:43], 0 idxen
    v_and_b32 v100, 0xffc, v18
    ds_add_rtn_u32 v50, v100, v9 offset:1024
    s_mov_b64 exec, s[6:7]
    v_lshlrev_b32 v64, 2, v101
    v_lshlrev_b32 v63, 1, v101
    ds_read_b128 v[66:69], v64 offset:8704
    ds_read_b64 v[70:71], v63 offset:3584
    v_mul_f32 v72, s81, v13
    v_fract_f32 v72, v72
    v_cos_f32 v72, v72
    s_nop 0
    v_add_f32 v75, v72, v72
    v_fma_f32 v73, v75, v72, -1.0
    v_fma_f32 v74, v75, v73, -v72
    v_cvt_pk_bf16_f32 v75, v72, v73
    v_cvt_pk_bf16_f32 v76, v74, 0
    v_lshlrev_b32 v77, 16, v76
    s_waitcnt lgkmcnt(0)
    v_dot2_f32_bf16 v78, v70, v76, 0
    v_dot2_f32_bf16 v79, v70, v77, 0
    v_dot2_f32_bf16 v80, v71, v76, 0
    v_dot2_f32_bf16 v81, v71, v77, 0
    v_mad_u32_u24 v65, v51, s80, v63
    s_nop 1
    v_dot2c_f32_bf16 v78, v66, v75
    v_dot2c_f32_bf16 v79, v67, v75
    v_dot2c_f32_bf16 v80, v68, v75
    v_dot2c_f32_bf16 v81, v69, v75
    s_waitcnt vmcnt(4)
    v_dot2_f32_bf16 v90, v44, s60, 0
    v_dot2_f32_bf16 v91, v44, s61, 0
    v_dot2_f32_bf16 v92, v44, s62, 0
    v_dot2_f32_bf16 v93, v44, s63, 0
    v_dot2c_f32_bf16 v90, s64, v45
    v_dot2c_f32_bf16 v91, s65, v45
    v_dot2c_f32_bf16 v92, s66, v45
    v_dot2c_f32_bf16 v93, s67, v45
    s_nop 0
    v_mul_f32 v90, v90, v78
    v_mul_f32 v91, v91, v79
    v_mul_f32 v92, v92, v80
    v_mul_f32 v93, v93, v81
    v_cvt_pk_bf16_f32 v94, v90, v91
    v_cvt_pk_bf16_f32 v95, v92, v93
    v_cmpx_gt_u32 vcc, 26, v51
    ds_write_b64 v65, v[94:95] offset:29184
    s_andn2_b64 exec, s[6:7], exec
    s_cbranch_scc0 L_ov_26
    ds_add_f32 v64, v90 offset:18944
    ds_add_f32 v64, v91 offset:18948
    ds_add_f32 v64, v92 offset:18952
    ds_add_f32 v64, v93 offset:18956
L_ov_26:
    s_mov_b64 exec, s[14:15]
    v_lshrrev_b32 v65, 12, v20
    buffer_load_dwordx2 v[44:45], v65, s[40:43], 0 idxen
    v_and_b32 v101, 0xffc, v20
    ds_add_rtn_u32 v51, v101, v9 offset:1024
    s_mov_b64 exec, s[8:9]
    v_lshlrev_b32 v64, 2, v102
    v_lshlrev_b32 v63, 1, v102
    ds_read_b128 v[66:69], v64 offset:8704
    ds_read_b64 v[70:71], v63 offset:3584
    v_mul_f32 v72, s81, v15
    v_fract_f32 v72, v72
    v_cos_f32 v72, v72
    s_nop 0
    v_add_f32 v75, v72, v72
    v_fma_f32 v73, v75, v72, -1.0
    v_fma_f32 v74, v75, v73, -v72
    v_cvt_pk_bf16_f32 v75, v72, v73
    v_cvt_pk_bf16_f32 v76, v74, 0
    v_lshlrev_b32 v77, 16, v76
    s_waitcnt lgkmcnt(0)
    v_dot2_f32_bf16 v78, v70, v76, 0
    v_dot2_f32_bf16 v79, v70, v77, 0
    v_dot2_f32_bf16 v80, v71, v76, 0
    v_dot2_f32_bf16 v81, v71, v77, 0
    v_mad_u32_u24 v65, v52, s80, v63
    s_nop 1
    v_dot2c_f32_bf16 v78, v66, v75
    v_dot2c_f32_bf16 v79, v67, v75
    v_dot2c_f32_bf16 v80, v68, v75
    v_dot2c_f32_bf16 v81, v69, v75
    s_waitcnt vmcnt(4)
    v_dot2_f32_bf16 v90, v46, s60, 0
    v_dot2_f32_bf16 v91, v46, s61, 0
    v_dot2_f32_bf16 v92, v46, s62, 0
    v_dot2_f32_bf16 v93, v46, s63, 0
    v_dot2c_f32_bf16 v90, s64, v47
    v_dot2c_f32_bf16 v91, s65, v47
    v_dot2c_f32_bf16 v92, s66, v47
    v_dot2c_f32_bf16 v93, s67, v47
    s_nop 0
    v_mul_f32 v90, v90, v78
    v_mul_f32 v91, v91, v79
    v_mul_f32 v92, v92, v80
    v_mul_f32 v93, v93, v81
    v_cvt_pk_bf16_f32 v94, v90, v91
    v_cvt_pk_bf16_f32 v95, v92, v93
    v_cmpx_gt_u32 vcc, 26, v52
    ds_write_b64 v65, v[94:95] offset:29184
    s_andn2_b64 exec, s[8:9], exec
    s_cbranch_scc0 L_ov_27
    ds_add_f32 v64, v90 offset:18944
    ds_add_f32 v64, v91 offset:18948
    ds_add_f32 v64, v92 offset:18952
    ds_add_f32 v64, v93 offset:18956
L_ov_27:
    s_mov_b64 exec, s[16:17]
    v_lshrrev_b32 v65, 12, v22
    buffer_load_dwordx2 v[46:47], v65, s[40:43], 0 idxen
    v_and_b32 v102, 0xffc, v22
    ds_add_rtn_u32 v52, v102, v9 offset:1024
    s_mov_b64 exec, s[10:11]
    v_lshlrev_b32 v64, 2, v103
    v_lshlrev_b32 v63, 1, v103
    ds_read_b128 v[66:69], v64 offset:8704
    ds_read_b64 v[70:71], v63 offset:3584
    v_mul_f32 v72, s81, v17
    v_fract_f32 v72, v72
    v_cos_f32 v72, v72
    s_nop 0
    v_add_f32 v75, v72, v72
    v_fma_f32 v73, v75, v72, -1.0
    v_fma_f32 v74, v75, v73, -v72
    v_cvt_pk_bf16_f32 v75, v72, v73
    v_cvt_pk_bf16_f32 v76, v74, 0
    v_lshlrev_b32 v77, 16, v76
    s_waitcnt lgkmcnt(0)
    v_dot2_f32_bf16 v78, v70, v76, 0
    v_dot2_f32_bf16 v79, v70, v77, 0
    v_dot2_f32_bf16 v80, v71, v76, 0
    v_dot2_f32_bf16 v81, v71, v77, 0
    v_mad_u32_u24 v65, v53, s80, v63
    s_nop 1
    v_dot2c_f32_bf16 v78, v66, v75
    v_dot2c_f32_bf16 v79, v67, v75
    v_dot2c_f32_bf16 v80, v68, v75
    v_dot2c_f32_bf16 v81, v69, v75
    s_waitcnt vmcnt(3)
    v_dot2_f32_bf16 v90, v48, s60, 0
    v_dot2_f32_bf16 v91, v48, s61, 0
    v_dot2_f32_bf16 v92, v48, s62, 0
    v_dot2_f32_bf16 v93, v48, s63, 0
    v_dot2c_f32_bf16 v90, s64, v49
    v_dot2c_f32_bf16 v91, s65, v49
    v_dot2c_f32_bf16 v92, s66, v49
    v_dot2c_f32_bf16 v93, s67, v49
    s_nop 0
    v_mul_f32 v90, v90, v78
    v_mul_f32 v91, v91, v79
    v_mul_f32 v92, v92, v80
    v_mul_f32 v93, v93, v81
    v_cvt_pk_bf16_f32 v94, v90, v91
    v_cvt_pk_bf16_f32 v95, v92, v93
    v_cmpx_gt_u32 vcc, 26, v53
    ds_write_b64 v65, v[94:95] offset:29184
    s_andn2_b64 exec, s[10:11], exec
    s_cbranch_scc0 L_ov_28
    ds_add_f32 v64, v90 offset:18944
    ds_add_f32 v64, v91 offset:18948
    ds_add_f32 v64, v92 offset:18952
    ds_add_f32 v64, v93 offset:18956
L_ov_28:
    s_mov_b64 exec, s[18:19]
    v_lshrrev_b32 v65, 12, v24
    buffer_load_dwordx2 v[48:49], v65, s[40:43], 0 idxen
    v_and_b32 v103, 0xffc, v24
    ds_add_rtn_u32 v53, v103, v9 offset:1024
    s_mov_b64 exec, s[12:13]
    v_lshlrev_b32 v64, 2, v100
    v_lshlrev_b32 v63, 1, v100
    ds_read_b128 v[66:69], v64 offset:8704
    ds_read_b64 v[70:71], v63 offset:3584
    v_mul_f32 v72, s81, v19
    v_fract_f32 v72, v72
    v_cos_f32 v72, v72
    s_nop 0
    v_add_f32 v75, v72, v72
    v_fma_f32 v73, v75, v72, -1.0
    v_fma_f32 v74, v75, v73, -v72
    v_cvt_pk_bf16_f32 v75, v72, v73
    v_cvt_pk_bf16_f32 v76, v74, 0
    v_lshlrev_b32 v77, 16, v76
    s_waitcnt lgkmcnt(0)
    v_dot2_f32_bf16 v78, v70, v76, 0
    v_dot2_f32_bf16 v79, v70, v77, 0
    v_dot2_f32_bf16 v80, v71, v76, 0
    v_dot2_f32_bf16 v81, v71, v77, 0
    v_mad_u32_u24 v65, v50, s80, v63
    s_nop 1
    v_dot2c_f32_bf16 v78, v66, v75
    v_dot2c_f32_bf16 v79, v67, v75
    v_dot2c_f32_bf16 v80, v68, v75
    v_dot2c_f32_bf16 v81, v69, v75
    s_waitcnt vmcnt(3)
    v_dot2_f32_bf16 v90, v42, s60, 0
    v_dot2_f32_bf16 v91, v42, s61, 0
    v_dot2_f32_bf16 v92, v42, s62, 0
    v_dot2_f32_bf16 v93, v42, s63, 0
    v_dot2c_f32_bf16 v90, s64, v43
    v_dot2c_f32_bf16 v91, s65, v43
    v_dot2c_f32_bf16 v92, s66, v43
    v_dot2c_f32_bf16 v93, s67, v43
    s_nop 0
    v_mul_f32 v90, v90, v78
    v_mul_f32 v91, v91, v79
    v_mul_f32 v92, v92, v80
    v_mul_f32 v93, v93, v81
    v_cvt_pk_bf16_f32 v94, v90, v91
    v_cvt_pk_bf16_f32 v95, v92, v93
    v_cmpx_gt_u32 vcc, 26, v50
    ds_write_b64 v65, v[94:95] offset:29184
    s_andn2_b64 exec, s[12:13], exec
    s_cbranch_scc0 L_ov_29
    ds_add_f32 v64, v90 offset:18944
    ds_add_f32 v64, v91 offset:18948
    ds_add_f32 v64, v92 offset:18952
    ds_add_f32 v64, v93 offset:18956
L_ov_29:
    s_mov_b64 exec, s[84:85]
    v_lshrrev_b32 v65, 12, v26
    buffer_load_dwordx2 v[42:43], v65, s[40:43], 0 idxen
    v_and_b32 v100, 0xffc, v26
    ds_add_rtn_u32 v50, v100, v9 offset:1024
    s_mov_b64 exec, s[14:15]
    v_lshlrev_b32 v64, 2, v101
    v_lshlrev_b32 v63, 1, v101
    ds_read_b128 v[66:69], v64 offset:8704
    ds_read_b64 v[70:71], v63 offset:3584
    v_mul_f32 v72, s81, v21
    v_fract_f32 v72, v72
    v_cos_f32 v72, v72
    s_nop 0
    v_add_f32 v75, v72, v72
    v_fma_f32 v73, v75, v72, -1.0
    v_fma_f32 v74, v75, v73, -v72
    v_cvt_pk_bf16_f32 v75, v72, v73
    v_cvt_pk_bf16_f32 v76, v74, 0
    v_lshlrev_b32 v77, 16, v76
    s_waitcnt lgkmcnt(0)
    v_dot2_f32_bf16 v78, v70, v76, 0
    v_dot2_f32_bf16 v79, v70, v77, 0
    v_dot2_f32_bf16 v80, v71, v76, 0
    v_dot2_f32_bf16 v81, v71, v77, 0
    v_mad_u32_u24 v65, v51, s80, v63
    s_nop 1
    v_dot2c_f32_bf16 v78, v66, v75
    v_dot2c_f32_bf16 v79, v67, v75
    v_dot2c_f32_bf16 v80, v68, v75
    v_dot2c_f32_bf16 v81, v69, v75
    s_waitcnt vmcnt(3)
    v_dot2_f32_bf16 v90, v44, s60, 0
    v_dot2_f32_bf16 v91, v44, s61, 0
    v_dot2_f32_bf16 v92, v44, s62, 0
    v_dot2_f32_bf16 v93, v44, s63, 0
    v_dot2c_f32_bf16 v90, s64, v45
    v_dot2c_f32_bf16 v91, s65, v45
    v_dot2c_f32_bf16 v92, s66, v45
    v_dot2c_f32_bf16 v93, s67, v45
    s_nop 0
    v_mul_f32 v90, v90, v78
    v_mul_f32 v91, v91, v79
    v_mul_f32 v92, v92, v80
    v_mul_f32 v93, v93, v81
    v_cvt_pk_bf16_f32 v94, v90, v91
    v_cvt_pk_bf16_f32 v95, v92, v93
    v_cmpx_gt_u32 vcc, 26, v51
    ds_write_b64 v65, v[94:95] offset:29184
    s_andn2_b64 exec, s[14:15], exec
    s_cbranch_scc0 L_ov_30
    ds_add_f32 v64, v90 offset:18944
    ds_add_f32 v64, v91 offset:18948
    ds_add_f32 v64, v92 offset:18952
    ds_add_f32 v64, v93 offset:18956
L_ov_30:
    s_mov_b64 exec, s[86:87]
    v_lshrrev_b32 v65, 12, v28
    buffer_load_dwordx2 v[44:45], v65, s[40:43], 0 idxen
    v_and_b32 v101, 0xffc, v28
    ds_add_rtn_u32 v51, v101, v9 offset:1024
    s_mov_b64 exec, s[16:17]
    v_lshlrev_b32 v64, 2, v102
    v_lshlrev_b32 v63, 1, v102
    ds_read_b128 v[66:69], v64 offset:8704
    ds_read_b64 v[70:71], v63 offset:3584
    v_mul_f32 v72, s81, v23
    v_fract_f32 v72, v72
    v_cos_f32 v72, v72
    s_nop 0
    v_add_f32 v75, v72, v72
    v_fma_f32 v73, v75, v72, -1.0
    v_fma_f32 v74, v75, v73, -v72
    v_cvt_pk_bf16_f32 v75, v72, v73
    v_cvt_pk_bf16_f32 v76, v74, 0
    v_lshlrev_b32 v77, 16, v76
    s_waitcnt lgkmcnt(0)
    v_dot2_f32_bf16 v78, v70, v76, 0
    v_dot2_f32_bf16 v79, v70, v77, 0
    v_dot2_f32_bf16 v80, v71, v76, 0
    v_dot2_f32_bf16 v81, v71, v77, 0
    v_mad_u32_u24 v65, v52, s80, v63
    s_nop 1
    v_dot2c_f32_bf16 v78, v66, v75
    v_dot2c_f32_bf16 v79, v67, v75
    v_dot2c_f32_bf16 v80, v68, v75
    v_dot2c_f32_bf16 v81, v69, v75
    s_waitcnt vmcnt(3)
    v_dot2_f32_bf16 v90, v46, s60, 0
    v_dot2_f32_bf16 v91, v46, s61, 0
    v_dot2_f32_bf16 v92, v46, s62, 0
    v_dot2_f32_bf16 v93, v46, s63, 0
    v_dot2c_f32_bf16 v90, s64, v47
    v_dot2c_f32_bf16 v91, s65, v47
    v_dot2c_f32_bf16 v92, s66, v47
    v_dot2c_f32_bf16 v93, s67, v47
    s_nop 0
    v_mul_f32 v90, v90, v78
    v_mul_f32 v91, v91, v79
    v_mul_f32 v92, v92, v80
    v_mul_f32 v93, v93, v81
    v_cvt_pk_bf16_f32 v94, v90, v91
    v_cvt_pk_bf16_f32 v95, v92, v93
    v_cmpx_gt_u32 vcc, 26, v52
    ds_write_b64 v65, v[94:95] offset:29184
    s_andn2_b64 exec, s[16:17], exec
    s_cbranch_scc0 L_ov_31
    ds_add_f32 v64, v90 offset:18944
    ds_add_f32 v64, v91 offset:18948
    ds_add_f32 v64, v92 offset:18952
    ds_add_f32 v64, v93 offset:18956
L_ov_31:
    s_mov_b64 exec, s[88:89]
    v_lshrrev_b32 v65, 12, v30
    buffer_load_dwordx2 v[46:47], v65, s[40:43], 0 idxen
    v_and_b32 v102, 0xffc, v30
    ds_add_rtn_u32 v52, v102, v9 offset:1024
    s_mov_b64 exec, s[18:19]
    v_lshlrev_b32 v64, 2, v103
    v_lshlrev_b32 v63, 1, v103
    ds_read_b128 v[66:69], v64 offset:8704
    ds_read_b64 v[70:71], v63 offset:3584
    v_mul_f32 v72, s81, v25
    v_fract_f32 v72, v72
    v_cos_f32 v72, v72
    s_nop 0
    v_add_f32 v75, v72, v72
    v_fma_f32 v73, v75, v72, -1.0
    v_fma_f32 v74, v75, v73, -v72
    v_cvt_pk_bf16_f32 v75, v72, v73
    v_cvt_pk_bf16_f32 v76, v74, 0
    v_lshlrev_b32 v77, 16, v76
    s_waitcnt lgkmcnt(0)
    v_dot2_f32_bf16 v78, v70, v76, 0
    v_dot2_f32_bf16 v79, v70, v77, 0
    v_dot2_f32_bf16 v80, v71, v76, 0
    v_dot2_f32_bf16 v81, v71, v77, 0
    v_mad_u32_u24 v65, v53, s80, v63
    s_nop 1
    v_dot2c_f32_bf16 v78, v66, v75
    v_dot2c_f32_bf16 v79, v67, v75
    v_dot2c_f32_bf16 v80, v68, v75
    v_dot2c_f32_bf16 v81, v69, v75
    s_waitcnt vmcnt(3)
    v_dot2_f32_bf16 v90, v48, s60, 0
    v_dot2_f32_bf16 v91, v48, s61, 0
    v_dot2_f32_bf16 v92, v48, s62, 0
    v_dot2_f32_bf16 v93, v48, s63, 0
    v_dot2c_f32_bf16 v90, s64, v49
    v_dot2c_f32_bf16 v91, s65, v49
    v_dot2c_f32_bf16 v92, s66, v49
    v_dot2c_f32_bf16 v93, s67, v49
    s_nop 0
    v_mul_f32 v90, v90, v78
    v_mul_f32 v91, v91, v79
    v_mul_f32 v92, v92, v80
    v_mul_f32 v93, v93, v81
    v_cvt_pk_bf16_f32 v94, v90, v91
    v_cvt_pk_bf16_f32 v95, v92, v93
    v_cmpx_gt_u32 vcc, 26, v53
    ds_write_b64 v65, v[94:95] offset:29184
    s_andn2_b64 exec, s[18:19], exec
    s_cbranch_scc0 L_ov_32
    ds_add_f32 v64, v90 offset:18944
    ds_add_f32 v64, v91 offset:18948
    ds_add_f32 v64, v92 offset:18952
    ds_add_f32 v64, v93 offset:18956
L_ov_32:
    s_mov_b64 exec, s[90:91]
    v_lshrrev_b32 v65, 12, v32
    buffer_load_dwordx2 v[48:49], v65, s[40:43], 0 idxen
    v_and_b32 v103, 0xffc, v32
    ds_add_rtn_u32 v53, v103, v9 offset:1024
    s_mov_b64 exec, s[84:85]
    v_lshlrev_b32 v64, 2, v100
    v_lshlrev_b32 v63, 1, v100
    ds_read_b128 v[66:69], v64 offset:8704
    ds_read_b64 v[70:71], v63 offset:3584
    v_mul_f32 v72, s81, v27
    v_fract_f32 v72, v72
    v_cos_f32 v72, v72
    s_nop 0
    v_add_f32 v75, v72, v72
    v_fma_f32 v73, v75, v72, -1.0
    v_fma_f32 v74, v75, v73, -v72
    v_cvt_pk_bf16_f32 v75, v72, v73
    v_cvt_pk_bf16_f32 v76, v74, 0
    v_lshlrev_b32 v77, 16, v76
    s_waitcnt lgkmcnt(0)
    v_dot2_f32_bf16 v78, v70, v76, 0
    v_dot2_f32_bf16 v79, v70, v77, 0
    v_dot2_f32_bf16 v80, v71, v76, 0
    v_dot2_f32_bf16 v81, v71, v77, 0
    v_mad_u32_u24 v65, v50, s80, v63
    s_nop 1
    v_dot2c_f32_bf16 v78, v66, v75
    v_dot2c_f32_bf16 v79, v67, v75
    v_dot2c_f32_bf16 v80, v68, v75
    v_dot2c_f32_bf16 v81, v69, v75
    s_waitcnt vmcnt(3)
    v_dot2_f32_bf16 v90, v42, s60, 0
    v_dot2_f32_bf16 v91, v42, s61, 0
    v_dot2_f32_bf16 v92, v42, s62, 0
    v_dot2_f32_bf16 v93, v42, s63, 0
    v_dot2c_f32_bf16 v90, s64, v43
    v_dot2c_f32_bf16 v91, s65, v43
    v_dot2c_f32_bf16 v92, s66, v43
    v_dot2c_f32_bf16 v93, s67, v43
    s_nop 0
    v_mul_f32 v90, v90, v78
    v_mul_f32 v91, v91, v79
    v_mul_f32 v92, v92, v80
    v_mul_f32 v93, v93, v81
    v_cvt_pk_bf16_f32 v94, v90, v91
    v_cvt_pk_bf16_f32 v95, v92, v93
    v_cmpx_gt_u32 vcc, 26, v50
    ds_write_b64 v65, v[94:95] offset:29184
    s_andn2_b64 exec, s[84:85], exec
    s_cbranch_scc0 L_ov_33
    ds_add_f32 v64, v90 offset:18944
    ds_add_f32 v64, v91 offset:18948
    ds_add_f32 v64, v92 offset:18952
    ds_add_f32 v64, v93 offset:18956
L_ov_33:
    s_mov_b64 exec, s[86:87]
    v_lshlrev_b32 v64, 2, v101
    v_lshlrev_b32 v63, 1, v101
    ds_read_b128 v[66:69], v64 offset:8704
    ds_read_b64 v[70:71], v63 offset:3584
    v_mul_f32 v72, s81, v29
    v_fract_f32 v72, v72
    v_cos_f32 v72, v72
    s_nop 0
    v_add_f32 v75, v72, v72
    v_fma_f32 v73, v75, v72, -1.0
    v_fma_f32 v74, v75, v73, -v72
    v_cvt_pk_bf16_f32 v75, v72, v73
    v_cvt_pk_bf16_f32 v76, v74, 0
    v_lshlrev_b32 v77, 16, v76
    s_waitcnt lgkmcnt(0)
    v_dot2_f32_bf16 v78, v70, v76, 0
    v_dot2_f32_bf16 v79, v70, v77, 0
    v_dot2_f32_bf16 v80, v71, v76, 0
    v_dot2_f32_bf16 v81, v71, v77, 0
    v_mad_u32_u24 v65, v51, s80, v63
    s_nop 1
    v_dot2c_f32_bf16 v78, v66, v75
    v_dot2c_f32_bf16 v79, v67, v75
    v_dot2c_f32_bf16 v80, v68, v75
    v_dot2c_f32_bf16 v81, v69, v75
    s_waitcnt vmcnt(2)
    v_dot2_f32_bf16 v90, v44, s60, 0
    v_dot2_f32_bf16 v91, v44, s61, 0
    v_dot2_f32_bf16 v92, v44, s62, 0
    v_dot2_f32_bf16 v93, v44, s63, 0
    v_dot2c_f32_bf16 v90, s64, v45
    v_dot2c_f32_bf16 v91, s65, v45
    v_dot2c_f32_bf16 v92, s66, v45
    v_dot2c_f32_bf16 v93, s67, v45
    s_nop 0
    v_mul_f32 v90, v90, v78
    v_mul_f32 v91, v91, v79
    v_mul_f32 v92, v92, v80
    v_mul_f32 v93, v93, v81
    v_cvt_pk_bf16_f32 v94, v90, v91
    v_cvt_pk_bf16_f32 v95, v92, v93
    v_cmpx_gt_u32 vcc, 26, v51
    ds_write_b64 v65, v[94:95] offset:29184
    s_andn2_b64 exec, s[86:87], exec
    s_cbranch_scc0 L_ov_34
    ds_add_f32 v64, v90 offset:18944
    ds_add_f32 v64, v91 offset:18948
    ds_add_f32 v64, v92 offset:18952
    ds_add_f32 v64, v93 offset:18956
L_ov_34:
    s_mov_b64 exec, s[88:89]
    v_lshlrev_b32 v64, 2, v102
    v_lshlrev_b32 v63, 1, v102
    ds_read_b128 v[66:69], v64 offset:8704
    ds_read_b64 v[70:71], v63 offset:3584
    v_mul_f32 v72, s81, v31
    v_fract_f32 v72, v72
    v_cos_f32 v72, v72
    s_nop 0
    v_add_f32 v75, v72, v72
    v_fma_f32 v73, v75, v72, -1.0
    v_fma_f32 v74, v75, v73, -v72
    v_cvt_pk_bf16_f32 v75, v72, v73
    v_cvt_pk_bf16_f32 v76, v74, 0
    v_lshlrev_b32 v77, 16, v76
    s_waitcnt lgkmcnt(0)
    v_dot2_f32_bf16 v78, v70, v76, 0
    v_dot2_f32_bf16 v79, v70, v77, 0
    v_dot2_f32_bf16 v80, v71, v76, 0
    v_dot2_f32_bf16 v81, v71, v77, 0
    v_mad_u32_u24 v65, v52, s80, v63
    s_nop 1
    v_dot2c_f32_bf16 v78, v66, v75
    v_dot2c_f32_bf16 v79, v67, v75
    v_dot2c_f32_bf16 v80, v68, v75
    v_dot2c_f32_bf16 v81, v69, v75
    s_waitcnt vmcnt(1)
    v_dot2_f32_bf16 v90, v46, s60, 0
    v_dot2_f32_bf16 v91, v46, s61, 0
    v_dot2_f32_bf16 v92, v46, s62, 0
    v_dot2_f32_bf16 v93, v46, s63, 0
    v_dot2c_f32_bf16 v90, s64, v47
    v_dot2c_f32_bf16 v91, s65, v47
    v_dot2c_f32_bf16 v92, s66, v47
    v_dot2c_f32_bf16 v93, s67, v47
    s_nop 0
    v_mul_f32 v90, v90, v78
    v_mul_f32 v91, v91, v79
    v_mul_f32 v92, v92, v80
    v_mul_f32 v93, v93, v81
    v_cvt_pk_bf16_f32 v94, v90, v91
    v_cvt_pk_bf16_f32 v95, v92, v93
    v_cmpx_gt_u32 vcc, 26, v52
    ds_write_b64 v65, v[94:95] offset:29184
    s_andn2_b64 exec, s[88:89], exec
    s_cbranch_scc0 L_ov_35
    ds_add_f32 v64, v90 offset:18944
    ds_add_f32 v64, v91 offset:18948
    ds_add_f32 v64, v92 offset:18952
    ds_add_f32 v64, v93 offset:18956
L_ov_35:
    s_mov_b64 exec, s[90:91]
    v_lshlrev_b32 v64, 2, v103
    v_lshlrev_b32 v63, 1, v103
    ds_read_b128 v[66:69], v64 offset:8704
    ds_read_b64 v[70:71], v63 offset:3584
    v_mul_f32 v72, s81, v33
    v_fract_f32 v72, v72
    v_cos_f32 v72, v72
    s_nop 0
    v_add_f32 v75, v72, v72
    v_fma_f32 v73, v75, v72, -1.0
    v_fma_f32 v74, v75, v73, -v72
    v_cvt_pk_bf16_f32 v75, v72, v73
    v_cvt_pk_bf16_f32 v76, v74, 0
    v_lshlrev_b32 v77, 16, v76
    s_waitcnt lgkmcnt(0)
    v_dot2_f32_bf16 v78, v70, v76, 0
    v_dot2_f32_bf16 v79, v70, v77, 0
    v_dot2_f32_bf16 v80, v71, v76, 0
    v_dot2_f32_bf16 v81, v71, v77, 0
    v_mad_u32_u24 v65, v53, s80, v63
    s_nop 1
    v_dot2c_f32_bf16 v78, v66, v75
    v_dot2c_f32_bf16 v79, v67, v75
    v_dot2c_f32_bf16 v80, v68, v75
    v_dot2c_f32_bf16 v81, v69, v75
    s_waitcnt vmcnt(0)
    v_dot2_f32_bf16 v90, v48, s60, 0
    v_dot2_f32_bf16 v91, v48, s61, 0
    v_dot2_f32_bf16 v92, v48, s62, 0
    v_dot2_f32_bf16 v93, v48, s63, 0
    v_dot2c_f32_bf16 v90, s64, v49
    v_dot2c_f32_bf16 v91, s65, v49
    v_dot2c_f32_bf16 v92, s66, v49
    v_dot2c_f32_bf16 v93, s67, v49
    s_nop 0
    v_mul_f32 v90, v90, v78
    v_mul_f32 v91, v91, v79
    v_mul_f32 v92, v92, v80
    v_mul_f32 v93, v93, v81
    v_cvt_pk_bf16_f32 v94, v90, v91
    v_cvt_pk_bf16_f32 v95, v92, v93
    v_cmpx_gt_u32 vcc, 26, v53
    ds_write_b64 v65, v[94:95] offset:29184
    s_andn2_b64 exec, s[90:91], exec
    s_cbranch_scc0 L_ov_36
    ds_add_f32 v64, v90 offset:18944
    ds_add_f32 v64, v91 offset:18948
    ds_add_f32 v64, v92 offset:18952
    ds_add_f32 v64, v93 offset:18956
L_ov_36:
    s_mov_b64 exec, -1
    s_cmp_lg_u32 s48, 0
    s_cbranch_scc1 L_main_21
    s_cmp_eq_u32 s31, 0
    s_cbranch_scc1 L_main_21
    s_mov_b32 s55, s31
    v_add_u32 v54, 162304, v55
L_ovl_37:
    v_cmpx_gt_u32 vcc, s55, v1
    ds_read_b64 v[10:11], v54
    s_waitcnt lgkmcnt(0)
    s_mov_b64 s[58:59], exec
    v_lshrrev_b32 v65, 12, v10
    buffer_load_dwordx2 v[42:43], v65, s[40:43], 0 idxen
    v_and_b32 v100, 0xffc, v10
    ds_add_rtn_u32 v50, v100, v9 offset:1024
    v_lshlrev_b32 v64, 2, v100
    v_lshlrev_b32 v63, 1, v100
    ds_read_b128 v[66:69], v64 offset:8704
    ds_read_b64 v[70:71], v63 offset:3584
    v_mul_f32 v72, s81, v11
    v_fract_f32 v72, v72
    v_cos_f32 v72, v72
    s_nop 0
    v_add_f32 v75, v72, v72
    v_fma_f32 v73, v75, v72, -1.0
    v_fma_f32 v74, v75, v73, -v72
    v_cvt_pk_bf16_f32 v75, v72, v73
    v_cvt_pk_bf16_f32 v76, v74, 0
    v_lshlrev_b32 v77, 16, v76
    s_waitcnt lgkmcnt(0)
    v_dot2_f32_bf16 v78, v70, v76, 0
    v_dot2_f32_bf16 v79, v70, v77, 0
    v_dot2_f32_bf16 v80, v71, v76, 0
    v_dot2_f32_bf16 v81, v71, v77, 0
    v_mad_u32_u24 v65, v50, s80, v63
    s_nop 1
    v_dot2c_f32_bf16 v78, v66, v75
    v_dot2c_f32_bf16 v79, v67, v75
    v_dot2c_f32_bf16 v80, v68, v75
    v_dot2c_f32_bf16 v81, v69, v75
    s_waitcnt vmcnt(0)
    v_dot2_f32_bf16 v90, v42, s60, 0
    v_dot2_f32_bf16 v91, v42, s61, 0
    v_dot2_f32_bf16 v92, v42, s62, 0
    v_dot2_f32_bf16 v93, v42, s63, 0
    v_dot2c_f32_bf16 v90, s64, v43
    v_dot2c_f32_bf16 v91, s65, v43
    v_dot2c_f32_bf16 v92, s66, v43
    v_dot2c_f32_bf16 v93, s67, v43
    s_nop 0
    v_mul_f32 v90, v90, v78
    v_mul_f32 v91, v91, v79
    v_mul_f32 v92, v92, v80
    v_mul_f32 v93, v93, v81
    v_cvt_pk_bf16_f32 v94, v90, v91
    v_cvt_pk_bf16_f32 v95, v92, v93
    v_cmpx_gt_u32 vcc, 26, v50
    ds_write_b64 v65, v[94:95] offset:29184
    s_andn2_b64 exec, s[58:59], exec
    s_cbranch_scc0 L_ov_38
    ds_add_f32 v64, v90 offset:18944
    ds_add_f32 v64, v91 offset:18948
    ds_add_f32 v64, v92 offset:18952
    ds_add_f32 v64, v93 offset:18956
L_ov_38:
    s_mov_b64 exec, -1
    v_add_u32 v54, 512, v54
    s_sub_i32 s55, s55, 64
    s_cmp_gt_i32 s55, 0
    s_cbranch_scc1 L_ovl_37
L_main_21:
    s_mov_b64 exec, -1
    s_cmp_gt_u32 s31, 128
    s_cselect_b32 s82, 0, 64
    v_cmp_lt_u32 vcc, s82, v8
    s_mul_i32 s83, s82, 6
    s_and_b32 s52, vcc_lo, 0xff
    s_and_b32 s53, vcc_hi, 0xff
    s_cmp_eq_u64 s[52:53], 0
    s_cbranch_scc1 L_tdone_39
    v_mul_u32_u24 v3, 12, v1
    v_lshlrev_b32 v2, 1, v1
L_tk_40:
    s_ff1_i32_b64 s54, s[52:53]
    s_bitset0_b64 s[52:53], s54
    v_readlane_b32 s55, v8, s54
    v_readlane_b32 s56, v7, s54
    v_readlane_b32 s57, v104, s54
    s_nop 3
    s_sub_u32 s55, s55, s82
    s_add_u32 s56, s56, s83
    s_cmp_eq_u32 s82, 0
    s_cselect_b32 s57, s57, 0
    s_lshr_b32 s76, s57, 16
    s_mov_b32 s77, 0
L_ti_41:
    v_sub_u32 v54, s55, v2
    v_cmpx_lt_i32 vcc, 0, v54
    buffer_load_dwordx3 v[10:12], v3, s[36:39], s56 offen
    s_waitcnt vmcnt(0)
    s_andn2_b64 exec, exec, s[76:77]
    s_mov_b32 s76, 0
    s_mov_b64 s[58:59], exec
    v_lshrrev_b32 v65, 12, v10
    buffer_load_dwordx2 v[42:43], v65, s[40:43], 0 idxen
    v_and_b32 v100, 0xffc, v10
    ds_add_rtn_u32 v50, v100, v9 offset:1024
    v_lshlrev_b32 v64, 2, v100
    v_lshlrev_b32 v63, 1, v100
    ds_read_b128 v[66:69], v64 offset:8704
    ds_read_b64 v[70:71], v63 offset:3584
    v_lshlrev_b32 v77, 16, v11
    v_mul_f32 v72, s81, v77
    v_fract_f32 v72, v72
    v_cos_f32 v72, v72
    s_nop 0
    v_add_f32 v75, v72, v72
    v_fma_f32 v73, v75, v72, -1.0
    v_fma_f32 v74, v75, v73, -v72
    v_cvt_pk_bf16_f32 v75, v72, v73
    v_cvt_pk_bf16_f32 v76, v74, 0
    v_lshlrev_b32 v77, 16, v76
    s_waitcnt lgkmcnt(0)
    v_dot2_f32_bf16 v78, v70, v76, 0
    v_dot2_f32_bf16 v79, v70, v77, 0
    v_dot2_f32_bf16 v80, v71, v76, 0
    v_dot2_f32_bf16 v81, v71, v77, 0
    v_mad_u32_u24 v65, v50, s80, v63
    s_nop 1
    v_dot2c_f32_bf16 v78, v66, v75
    v_dot2c_f32_bf16 v79, v67, v75
    v_dot2c_f32_bf16 v80, v68, v75
    v_dot2c_f32_bf16 v81, v69, v75
    s_waitcnt vmcnt(0)
    v_dot2_f32_bf16 v90, v42, s60, 0
    v_dot2_f32_bf16 v91, v42, s61, 0
    v_dot2_f32_bf16 v92, v42, s62, 0
    v_dot2_f32_bf16 v93, v42, s63, 0
    v_dot2c_f32_bf16 v90, s64, v43
    v_dot2c_f32_bf16 v91, s65, v43
    v_dot2c_f32_bf16 v92, s66, v43
    v_dot2c_f32_bf16 v93, s67, v43
    s_nop 0
    v_mul_f32 v90, v90, v78
    v_mul_f32 v91, v91, v79
    v_mul_f32 v92, v92, v80
    v_mul_f32 v93, v93, v81
    v_cvt_pk_bf16_f32 v94, v90, v91
    v_cvt_pk_bf16_f32 v95, v92, v93
    v_cmpx_gt_u32 vcc, 26, v50
    ds_write_b64 v65, v[94:95] offset:29184
    s_andn2_b64 exec, s[58:59], exec
    s_cbranch_scc0 L_ov_42
    ds_add_f32 v64, v90 offset:18944
    ds_add_f32 v64, v91 offset:18948
    ds_add_f32 v64, v92 offset:18952
    ds_add_f32 v64, v93 offset:18956
L_ov_42:
    s_mov_b64 exec, -1
    v_cmpx_lt_i32 vcc, 1, v54
    s_mov_b64 s[58:59], exec
    v_lshrrev_b32 v65, 12, v12
    buffer_load_dwordx2 v[42:43], v65, s[40:43], 0 idxen
    v_and_b32 v100, 0xffc, v12
    ds_add_rtn_u32 v50, v100, v9 offset:1024
    v_lshlrev_b32 v64, 2, v100
    v_lshlrev_b32 v63, 1, v100
    ds_read_b128 v[66:69], v64 offset:8704
    ds_read_b64 v[70:71], v63 offset:3584
    v_and_b32 v77, 0xffff0000, v11
    v_mul_f32 v72, s81, v77
    v_fract_f32 v72, v72
    v_cos_f32 v72, v72
    s_nop 0
    v_add_f32 v75, v72, v72
    v_fma_f32 v73, v75, v72, -1.0
    v_fma_f32 v74, v75, v73, -v72
    v_cvt_pk_bf16_f32 v75, v72, v73
    v_cvt_pk_bf16_f32 v76, v74, 0
    v_lshlrev_b32 v77, 16, v76
    s_waitcnt lgkmcnt(0)
    v_dot2_f32_bf16 v78, v70, v76, 0
    v_dot2_f32_bf16 v79, v70, v77, 0
    v_dot2_f32_bf16 v80, v71, v76, 0
    v_dot2_f32_bf16 v81, v71, v77, 0
    v_mad_u32_u24 v65, v50, s80, v63
    s_nop 1
    v_dot2c_f32_bf16 v78, v66, v75
    v_dot2c_f32_bf16 v79, v67, v75
    v_dot2c_f32_bf16 v80, v68, v75
    v_dot2c_f32_bf16 v81, v69, v75
    s_waitcnt vmcnt(0)
    v_dot2_f32_bf16 v90, v42, s60, 0
    v_dot2_f32_bf16 v91, v42, s61, 0
    v_dot2_f32_bf16 v92, v42, s62, 0
    v_dot2_f32_bf16 v93, v42, s63, 0
    v_dot2c_f32_bf16 v90, s64, v43
    v_dot2c_f32_bf16 v91, s65, v43
    v_dot2c_f32_bf16 v92, s66, v43
    v_dot2c_f32_bf16 v93, s67, v43
    s_nop 0
    v_mul_f32 v90, v90, v78
    v_mul_f32 v91, v91, v79
    v_mul_f32 v92, v92, v80
    v_mul_f32 v93, v93, v81
    v_cvt_pk_bf16_f32 v94, v90, v91
    v_cvt_pk_bf16_f32 v95, v92, v93
    v_cmpx_gt_u32 vcc, 26, v50
    ds_write_b64 v65, v[94:95] offset:29184
    s_andn2_b64 exec, s[58:59], exec
    s_cbranch_scc0 L_ov_43
    ds_add_f32 v64, v90 offset:18944
    ds_add_f32 v64, v91 offset:18948
    ds_add_f32 v64, v92 offset:18952
    ds_add_f32 v64, v93 offset:18956
L_ov_43:
    s_mov_b64 exec, -1
    s_add_u32 s56, s56, 768
    s_sub_i32 s55, s55, 128
    s_cmp_gt_i32 s55, 0
    s_cbranch_scc1 L_ti_41
    s_cmp_lg_u64 s[52:53], 0
    s_cbranch_scc1 L_tk_40
L_tdone_39:
    s_mov_b64 exec, -1
    s_cmp_ge_u32 s48, 10
    s_cbranch_scc1 L_pre_44
    v_add_u32 v68, 40960, v5
    v_add_u32 v69, 81920, v5
    v_add_u32 v70, 122880, v5
    s_mov_b32 s52, 0x00003f80
    s_mov_b32 s53, 0x3f800000
    s_lshl_b32 s4, s68, 16
    s_and_b32 s5, s68, 0xffff0000
    s_lshl_b32 s6, s69, 16
    s_and_b32 s7, s69, 0xffff0000
    s_lshl_b32 s8, s70, 16
    s_and_b32 s9, s70, 0xffff0000
    s_lshl_b32 s10, s71, 16
    s_and_b32 s11, s71, 0xffff0000
    s_lshl_b32 s12, s72, 16
    s_and_b32 s13, s72, 0xffff0000
    s_lshl_b32 s14, s73, 16
    s_and_b32 s15, s73, 0xffff0000
    s_lshl_b32 s16, s74, 16
    s_and_b32 s17, s74, 0xffff0000
    s_lshl_b32 s18, s75, 16
    s_and_b32 s19, s75, 0xffff0000
    s_mov_b32 s32, s26
    s_mov_b32 s33, s27
    s_mov_b32 s34, 0x138800
    s_mov_b32 s35, 0x20000
    s_mul_i32 s49, s3, 5000
    s_waitcnt vmcnt(0)
    v_lshlrev_b32 v76, 16, v98
    v_and_b32 v77, 0xffff0000, v98
    v_lshlrev_b32 v78, 16, v99
    v_and_b32 v79, 0xffff0000, v99
    v_lshlrev_b32 v82, 16, v96
    v_and_b32 v83, 0xffff0000, v96
    v_lshlrev_b32 v84, 16, v97
    v_and_b32 v85, 0xffff0000, v97
L_pre_44:
    s_waitcnt lgkmcnt(0)
    s_barrier
    s_cmp_ge_u32 s48, 10
    s_cbranch_scc1 L_fin_45
    ds_read_b32 v62, v4 offset:1024
    ds_read_b128 v[64:67], v6 offset:18944
    ds_read_b64 v[10:11], v5 offset:29184
    ds_read_b64 v[12:13], v5 offset:34304
    ds_read_b64 v[14:15], v5 offset:39424
    ds_read_b64 v[16:17], v5 offset:44544
    ds_read_b64 v[18:19], v5 offset:49664
    ds_read_b64 v[20:21], v5 offset:54784
    ds_read_b64 v[22:23], v5 offset:59904
    ds_read_b64 v[24:25], v5 offset:65024
    ds_read_b64 v[26:27], v68 offset:29184
    ds_read_b64 v[28:29], v68 offset:34304
    ds_read_b64 v[30:31], v68 offset:39424
    ds_read_b64 v[32:33], v68 offset:44544
    ds_read_b64 v[34:35], v68 offset:49664
    ds_read_b64 v[36:37], v68 offset:54784
    ds_read_b64 v[38:39], v68 offset:59904
    ds_read_b64 v[40:41], v68 offset:65024
    s_waitcnt lgkmcnt(12)
    v_cmpx_lt_u32 vcc, 0, v62
    v_dot2c_f32_bf16 v64, s52, v10
    v_dot2c_f32_bf16 v65, s53, v10
    v_dot2c_f32_bf16 v66, s52, v11
    v_dot2c_f32_bf16 v67, s53, v11
    v_cmpx_lt_u32 vcc, 1, v62
    v_dot2c_f32_bf16 v64, s52, v12
    v_dot2c_f32_bf16 v65, s53, v12
    v_dot2c_f32_bf16 v66, s52, v13
    v_dot2c_f32_bf16 v67, s53, v13
    v_cmpx_lt_u32 vcc, 2, v62
    v_dot2c_f32_bf16 v64, s52, v14
    v_dot2c_f32_bf16 v65, s53, v14
    v_dot2c_f32_bf16 v66, s52, v15
    v_dot2c_f32_bf16 v67, s53, v15
    v_cmpx_lt_u32 vcc, 3, v62
    v_dot2c_f32_bf16 v64, s52, v16
    v_dot2c_f32_bf16 v65, s53, v16
    v_dot2c_f32_bf16 v66, s52, v17
    v_dot2c_f32_bf16 v67, s53, v17
    s_waitcnt lgkmcnt(8)
    v_cmpx_lt_u32 vcc, 4, v62
    v_dot2c_f32_bf16 v64, s52, v18
    v_dot2c_f32_bf16 v65, s53, v18
    v_dot2c_f32_bf16 v66, s52, v19
    v_dot2c_f32_bf16 v67, s53, v19
    v_cmpx_lt_u32 vcc, 5, v62
    v_dot2c_f32_bf16 v64, s52, v20
    v_dot2c_f32_bf16 v65, s53, v20
    v_dot2c_f32_bf16 v66, s52, v21
    v_dot2c_f32_bf16 v67, s53, v21
    v_cmpx_lt_u32 vcc, 6, v62
    v_dot2c_f32_bf16 v64, s52, v22
    v_dot2c_f32_bf16 v65, s53, v22
    v_dot2c_f32_bf16 v66, s52, v23
    v_dot2c_f32_bf16 v67, s53, v23
    v_cmpx_lt_u32 vcc, 7, v62
    v_dot2c_f32_bf16 v64, s52, v24
    v_dot2c_f32_bf16 v65, s53, v24
    v_dot2c_f32_bf16 v66, s52, v25
    v_dot2c_f32_bf16 v67, s53, v25
    s_waitcnt lgkmcnt(4)
    v_cmpx_lt_u32 vcc, 8, v62
    v_dot2c_f32_bf16 v64, s52, v26
    v_dot2c_f32_bf16 v65, s53, v26
    v_dot2c_f32_bf16 v66, s52, v27
    v_dot2c_f32_bf16 v67, s53, v27
    v_cmpx_lt_u32 vcc, 9, v62
    v_dot2c_f32_bf16 v64, s52, v28
    v_dot2c_f32_bf16 v65, s53, v28
    v_dot2c_f32_bf16 v66, s52, v29
    v_dot2c_f32_bf16 v67, s53, v29
    v_cmpx_lt_u32 vcc, 10, v62
    v_dot2c_f32_bf16 v64, s52, v30
    v_dot2c_f32_bf16 v65, s53, v30
    v_dot2c_f32_bf16 v66, s52, v31
    v_dot2c_f32_bf16 v67, s53, v31
    v_cmpx_lt_u32 vcc, 11, v62
    v_dot2c_f32_bf16 v64, s52, v32
    v_dot2c_f32_bf16 v65, s53, v32
    v_dot2c_f32_bf16 v66, s52, v33
    v_dot2c_f32_bf16 v67, s53, v33
    s_waitcnt lgkmcnt(0)
    v_cmpx_lt_u32 vcc, 12, v62
    v_dot2c_f32_bf16 v64, s52, v34
    v_dot2c_f32_bf16 v65, s53, v34
    v_dot2c_f32_bf16 v66, s52, v35
    v_dot2c_f32_bf16 v67, s53, v35
    v_cmpx_lt_u32 vcc, 13, v62
    v_dot2c_f32_bf16 v64, s52, v36
    v_dot2c_f32_bf16 v65, s53, v36
    v_dot2c_f32_bf16 v66, s52, v37
    v_dot2c_f32_bf16 v67, s53, v37
    v_cmpx_lt_u32 vcc, 14, v62
    v_dot2c_f32_bf16 v64, s52, v38
    v_dot2c_f32_bf16 v65, s53, v38
    v_dot2c_f32_bf16 v66, s52, v39
    v_dot2c_f32_bf16 v67, s53, v39
    v_cmpx_lt_u32 vcc, 15, v62
    v_dot2c_f32_bf16 v64, s52, v40
    v_dot2c_f32_bf16 v65, s53, v40
    v_dot2c_f32_bf16 v66, s52, v41
    v_dot2c_f32_bf16 v67, s53, v41
    v_cmp_lt_u32 vcc, 16, v62
    s_cbranch_vccz L_rd_46
    ds_read_b64 v[10:11], v69 offset:29184
    ds_read_b64 v[12:13], v69 offset:34304
    ds_read_b64 v[14:15], v69 offset:39424
    ds_read_b64 v[16:17], v69 offset:44544
    s_waitcnt lgkmcnt(0)
    v_cmpx_lt_u32 vcc, 16, v62
    v_dot2c_f32_bf16 v64, s52, v10
    v_dot2c_f32_bf16 v65, s53, v10
    v_dot2c_f32_bf16 v66, s52, v11
    v_dot2c_f32_bf16 v67, s53, v11
    v_cmpx_lt_u32 vcc, 17, v62
    v_dot2c_f32_bf16 v64, s52, v12
    v_dot2c_f32_bf16 v65, s53, v12
    v_dot2c_f32_bf16 v66, s52, v13
    v_dot2c_f32_bf16 v67, s53, v13
    v_cmpx_lt_u32 vcc, 18, v62
    v_dot2c_f32_bf16 v64, s52, v14
    v_dot2c_f32_bf16 v65, s53, v14
    v_dot2c_f32_bf16 v66, s52, v15
    v_dot2c_f32_bf16 v67, s53, v15
    v_cmpx_lt_u32 vcc, 19, v62
    v_dot2c_f32_bf16 v64, s52, v16
    v_dot2c_f32_bf16 v65, s53, v16
    v_dot2c_f32_bf16 v66, s52, v17
    v_dot2c_f32_bf16 v67, s53, v17
    v_cmp_lt_u32 vcc, 20, v62
    s_cbranch_vccz L_rd_46
    ds_read_b64 v[10:11], v69 offset:49664
    ds_read_b64 v[12:13], v69 offset:54784
    ds_read_b64 v[14:15], v69 offset:59904
    ds_read_b64 v[16:17], v69 offset:65024
    s_waitcnt lgkmcnt(0)
    v_cmpx_lt_u32 vcc, 20, v62
    v_dot2c_f32_bf16 v64, s52, v10
    v_dot2c_f32_bf16 v65, s53, v10
    v_dot2c_f32_bf16 v66, s52, v11
    v_dot2c_f32_bf16 v67, s53, v11
    v_cmpx_lt_u32 vcc, 21, v62
    v_dot2c_f32_bf16 v64, s52, v12
    v_dot2c_f32_bf16 v65, s53, v12
    v_dot2c_f32_bf16 v66, s52, v13
    v_dot2c_f32_bf16 v67, s53, v13
    v_cmpx_lt_u32 vcc, 22, v62
    v_dot2c_f32_bf16 v64, s52, v14
    v_dot2c_f32_bf16 v65, s53, v14
    v_dot2c_f32_bf16 v66, s52, v15
    v_dot2c_f32_bf16 v67, s53, v15
    v_cmpx_lt_u32 vcc, 23, v62
    v_dot2c_f32_bf16 v64, s52, v16
    v_dot2c_f32_bf16 v65, s53, v16
    v_dot2c_f32_bf16 v66, s52, v17
    v_dot2c_f32_bf16 v67, s53, v17
    v_cmp_lt_u32 vcc, 24, v62
    s_cbranch_vccz L_rd_46
    ds_read_b64 v[10:11], v70 offset:29184
    ds_read_b64 v[12:13], v70 offset:34304
    s_waitcnt lgkmcnt(0)
    v_cmpx_lt_u32 vcc, 24, v62
    v_dot2c_f32_bf16 v64, s52, v10
    v_dot2c_f32_bf16 v65, s53, v10
    v_dot2c_f32_bf16 v66, s52, v11
    v_dot2c_f32_bf16 v67, s53, v11
    v_cmpx_lt_u32 vcc, 25, v62
    v_dot2c_f32_bf16 v64, s52, v12
    v_dot2c_f32_bf16 v65, s53, v12
    v_dot2c_f32_bf16 v66, s52, v13
    v_dot2c_f32_bf16 v67, s53, v13
L_rd_46:
    s_mov_b64 exec, -1
    s_nop 1
    v_mul_f32 v72, s4, v64
    v_mul_f32 v73, s5, v64
    v_mul_f32 v74, s6, v64
    v_mul_f32 v75, s7, v64
    v_fmac_f32 v72, s8, v65
    v_fmac_f32 v73, s9, v65
    v_fmac_f32 v74, s10, v65
    v_fmac_f32 v75, s11, v65
    v_fmac_f32 v72, s12, v66
    v_fmac_f32 v73, s13, v66
    v_fmac_f32 v74, s14, v66
    v_fmac_f32 v75, s15, v66
    v_fmac_f32 v72, s16, v67
    v_fmac_f32 v73, s17, v67
    v_fmac_f32 v74, s18, v67
    v_fmac_f32 v75, s19, v67
    v_fmac_f32 v76, v72, v82
    v_fmac_f32 v77, v73, v83
    v_fmac_f32 v78, v74, v84
    v_fmac_f32 v79, v75, v85
    v_cvt_pk_bf16_f32 v80, v76, v77
    v_cvt_pk_bf16_f32 v81, v78, v79
    v_cmpx_gt_u32 vcc, 625, v0
    buffer_store_dwordx2 v[80:81], v5, s[32:35], s49 offen
L_fin_45:
L_k2_done:
    s_endpgm
.section .rodata,"a"
.p2align 6
.amdhsa_kernel standalone__molecular_angular_gemnet__graph_part_kernel
  .amdhsa_next_free_vgpr 92
  .amdhsa_next_free_sgpr 48
  .amdhsa_accum_offset 92
  .amdhsa_group_segment_fixed_size 0
  .amdhsa_kernarg_size 112
  .amdhsa_user_sgpr_count 2
  .amdhsa_user_sgpr_kernarg_segment_ptr 1
  .amdhsa_system_sgpr_workgroup_id_x 1
  .amdhsa_float_denorm_mode_32 3
.end_amdhsa_kernel
.p2align 6
.amdhsa_kernel standalone__molecular_angular_gemnet__graph_kernel
  .amdhsa_next_free_vgpr 120
  .amdhsa_next_free_sgpr 102
  .amdhsa_accum_offset 120
  .amdhsa_group_segment_fixed_size 0
  .amdhsa_kernarg_size 112
  .amdhsa_user_sgpr_count 2
  .amdhsa_user_sgpr_kernarg_segment_ptr 1
  .amdhsa_system_sgpr_workgroup_id_x 1
  .amdhsa_float_denorm_mode_32 3
.end_amdhsa_kernel
```
